```python
import torch

def _softmax(x, axis=-1):
    return torch.softmax(x, dim=axis)
def _gelu(x):
    return torch.nn.functional.gelu(x, approximate="tanh")
def _silu(x):
    return torch.nn.functional.silu(x)
def _sigmoid(x):
    return torch.sigmoid(x)
def _layernorm(x, axis=-1, eps=1e-5):
    m = x.mean(dim=axis, keepdim=True)
    v = x.var(dim=axis, keepdim=True, unbiased=False)
    return (x - m) / torch.sqrt(v + eps)
def _scatter_add(tgt, idx, src, axis=0):
    return tgt.clone().index_add_(axis, idx, src)
def _segment_sum(src, seg, n):
    out = torch.zeros((n,) + src.shape[1:], dtype=src.dtype)
    return out.index_add_(0, seg, src)
def _pad(x, pw):
    flat = tuple(v for pair in reversed(pw) for v in pair)
    return torch.nn.functional.pad(x, flat)

kernel_name = 'parallel_sum__mha_block_cached__mixer_token_mlp__decode'

def setup_inputs():

    _w = (lambda a: (lambda t: t.to(torch.bfloat16) if t.is_floating_point() else t)(torch.as_tensor(a)))
    def _A_setup():
        B, Sq, D = 8, 1, 512
        H, Sk, Dh = 32, 4096, 128
        return {
            "x": _w((lambda *s: torch.randn(*s, dtype=torch.bfloat16) * 0.05)(B, Sq, D)),
            "k_cache": _w((lambda *s: torch.randn(*s, dtype=torch.bfloat16) * 3.2)(B, H, Sk, Dh)),
            "v_cache": _w((lambda *s: torch.randn(*s, dtype=torch.bfloat16) * 0.8)(B, H, Sk, Dh)),
            "wq": _w((lambda *s: torch.randn(*s, dtype=torch.bfloat16) * 3.2)(D, H * Dh) * (D ** -0.5)),
            "wo": _w((lambda *s: torch.randn(*s, dtype=torch.bfloat16) * 0.8)(H * Dh, D) * ((H * Dh) ** -0.5)),
        }
    _A_in = _A_setup()

    def _B_setup():
        B, S, D, F = 8, 1, 512, 1792
        return {
            "x": _w((lambda *s: torch.randn(*s, dtype=torch.bfloat16) * 0.05)(B, S, D)),
            "w1": _w((lambda *s: torch.randn(*s, dtype=torch.bfloat16) * 3.2)(S, F) * (S ** -0.5)),
            "b1": _w((lambda *s: torch.randn(*s, dtype=torch.bfloat16) * 3.2)(F) * 0.02),
            "w2": _w((lambda *s: torch.randn(*s, dtype=torch.bfloat16) * 0.8)(F, S) * (F ** -0.5)),
            "b2": _w((lambda *s: torch.randn(*s, dtype=torch.bfloat16) * 0.8)(S) * 0.02),
        }
    _B_in = _B_setup()

    return {
        "A_x": _A_in["x"],
        "A_k_cache": _A_in["k_cache"],
        "A_v_cache": _A_in["v_cache"],
        "A_wq": _A_in["wq"],
        "A_wo": _A_in["wo"],
        "B_x": _B_in["x"],
        "B_w1": _B_in["w1"],
        "B_b1": _B_in["b1"],
        "B_w2": _B_in["w2"],
        "B_b2": _B_in["b2"],
    }

def reference(A_x, A_k_cache, A_v_cache, A_wq, A_wo, B_x, B_w1, B_b1, B_w2, B_b2):
    def _A_ref(x, k_cache, v_cache, wq, wo):
        B, Sq, D = x.shape
        H, Dh = 32, 128
        q = (lambda x, *d: x.permute(*d))((x @ wq).reshape(B, Sq, H, Dh), 0, 2, 1, 3)
        scores = torch.einsum("bhqd,bhkd->bhqk", q, k_cache) * (Dh ** -0.5)
        p = _softmax(scores, axis=-1)
        o = torch.einsum("bhqk,bhkd->bhqd", p, v_cache)
        return (lambda x, *d: x.permute(*d))(o, 0, 2, 1, 3).reshape(B, Sq, H * Dh) @ wo

    def _B_ref(x, w1, b1, w2, b2):
        B, S, D = x.shape
        h = _layernorm(x, axis=-1)
        u = torch.einsum("bsd,sf->bdf", h, w1) + b1
        u = _gelu(u)
        y = torch.einsum("bdf,fs->bds", u, w2) + b2
        return (lambda x, *d: x.permute(*d))(y, 0, 2, 1)

    x = A_x
    xn = _layernorm(x, axis=-1)
    return x + _A_ref(xn, A_k_cache, A_v_cache, A_wq, A_wo) + _B_ref(xn, B_w1, B_b1, B_w2, B_b2)
```

```asm
; @launch grid=(256,1,1) block=(512,1,1) lds=145408
.amdgcn_target "amdgcn-amd-amdhsa--gfx950"
.text
.globl parallel_sum__mha_block_cached__mixer_token_mlp__decode_kernel
.p2align 8
.type parallel_sum__mha_block_cached__mixer_token_mlp__decode_kernel,@function
parallel_sum__mha_block_cached__mixer_token_mlp__decode_kernel:
    s_cmp_ge_u32 s2, 256
    s_cbranch_scc1 L_end
    s_load_dwordx4 s[52:55], s[0:1], 8
    s_load_dwordx2 s[28:29], s[0:1], 96
    s_add_u32 s3, s2, 2
    s_and_b32 s3, s3, 7
    s_and_b32 s2, s2, 0xf8
    s_or_b32 s2, s2, s3
    s_mov_b32 s96, s2
    s_bfe_u32 s3, s2, 0x20003
    s_xor_b32 s2, s2, s3
    v_lshrrev_b32 v1, 6, v0
    v_and_b32 v5, 63, v0
    v_readfirstlane_b32 s3, v1
    s_nop 0
    s_cmp_ge_u32 s3, 4
    s_cbranch_scc1 L_aux
    s_setprio 3
    v_lshlrev_b32 v1, 4, v5
    s_and_b32 s16, s3, 2
    s_lshl_b32 s16, s16, 14
    s_and_b32 s15, s2, 2
    s_lshl_b32 s15, s15, 15
    s_or_b32 s16, s16, s15
    v_add_u32 v1, s16, v1
    v_add_u32 v2, 0x1000, v1
    v_xor_b32 v3, 65536, v1
    v_xor_b32 v4, 65536, v2
    s_and_b32 s15, s2, 28
    s_lshl_b32 s15, s15, 15
    s_and_b32 s16, s3, 1
    s_lshl_b32 s16, s16, 13
    s_or_b32 s15, s15, s16
    s_and_b32 s16, s2, 4
    s_lshl_b32 s16, s16, 20
    s_or_b32 s15, s15, s16
    s_lshl_b32 s17, s2, 20
    s_and_b32 s17, s17, 0xffbfffff
    s_mov_b32 s10, 5242880
    s_mov_b32 s11, 0x20000
    s_lshl_b32 s14, s2, 12
    s_and_b32 s27, s2, 1
    s_lshl_b32 s27, s27, 14
    s_or_b32 s15, s15, s27
    s_and_b32 s16, s14, 0xe0000
    s_lshr_b32 s27, s14, 6
    s_and_b32 s27, s27, 0x4000
    s_or_b32 s16, s16, s27
    s_xor_b32 s16, s16, s15
    s_lshl_b32 s18, s3, 15
    s_add_u32 m0, s18, 14336
    s_waitcnt lgkmcnt(0)
    s_add_u32 s8, s52, s17
    s_addc_u32 s9, s53, 0
    buffer_load_dwordx4 v1, s[8:11], s16 offen nt lds
    buffer_load_dwordx4 v1, s[8:11], s16 offen offset:1024 nt lds
    buffer_load_dwordx4 v1, s[8:11], s16 offen offset:2048 nt lds
    buffer_load_dwordx4 v1, s[8:11], s16 offen offset:3072 nt lds
    s_add_u32 m0, m0, 4096
    s_nop 0
    buffer_load_dwordx4 v2, s[8:11], s16 offen nt lds
    buffer_load_dwordx4 v2, s[8:11], s16 offen offset:1024 nt lds
    buffer_load_dwordx4 v2, s[8:11], s16 offen offset:2048 nt lds
    s_add_u32 s12, s54, s17
    s_addc_u32 s13, s55, 0
    s_add_u32 s44, s28, 0
    s_addc_u32 s45, s29, 0
    s_mov_b32 s46, 0x100000
    s_mov_b32 s47, 0x20000
    s_mov_b32 s20, 0xcccccccc
    s_mov_b32 s21, 0xcccccccc
    s_mov_b32 s22, 0xaaaaaaaa
    s_mov_b32 s23, 0xaaaaaaaa
    s_mov_b32 s24, 0x3db504f3
    s_mov_b32 s25, 0x3fb8aa3b
    s_mov_b32 s26, 0xffff0000
    v_mov_b32 v32, 0
    v_mov_b32 v33, 0
    v_mov_b32 v34, 0
    v_mov_b32 v35, 0
    v_mov_b32 v36, 0
    v_mov_b32 v37, 0
    v_mov_b32 v38, 0
    v_mov_b32 v39, 0
    v_and_b32 v6, 15, v5
    v_lshlrev_b32 v6, 5, v6
    v_lshrrev_b32 v7, 4, v5
    v_lshl_add_u32 v7, v7, 3, v6
    s_lshl_b32 s18, s3, 9
    v_lshl_add_u32 v74, v5, 3, s18
    s_add_u32 s18, s18, 2048
    v_add_u32 v7, s18, v7
    s_lshl_b32 s18, s3, 4
    s_add_u32 s18, s18, 4096
    v_mov_b32 v72, s18
    s_lshl_b32 s18, s3, 2
    v_mov_b32 v73, s18
    s_lshl_b32 s18, s3, 3
    v_mov_b32 v57, s18
    v_mov_b32 v56, 4096
    s_memrealtime s[34:35]
    s_mov_b32 s30, 0
    s_mov_b32 s31, 0
    s_mov_b64 vcc, 0
    s_mov_b32 s17, 0
    s_mov_b32 s40, 0
    s_mov_b32 s41, 18
    s_mov_b32 s50, 17
    s_lshr_b32 s18, s3, 1
    s_lshl_b32 s18, s18, 2
    v_mov_b32 v124, v73
    v_lshl_add_u32 v125, v5, 3, s18
    s_mov_b32 s43, 0
    s_lshl_b32 s18, s18, 7
    v_and_b32 v126, 0x1ff, v7
    v_add_u32 v126, s18, v126
    v_mov_b32 v116, 0
    v_mov_b32 v117, 0
    v_mov_b32 v118, 0
    v_mov_b32 v119, 0
    v_mov_b32 v120, 0
    v_mov_b32 v121, 0
    v_mov_b32 v122, 0
    v_mov_b32 v123, 0
    s_lshr_b32 s33, s2, 5
    s_lshl_b32 s33, s33, 2
    s_and_b32 s36, s96, 3
    s_or_b32 s33, s33, s36
    s_mul_i32 s33, s33, 37
    s_and_b32 s33, s33, 31
    s_mul_i32 s42, s33, 11
    s_lshr_b32 s42, s42, 5
    s_add_u32 s42, s42, 19
    s_lshr_b32 s33, s2, 3
    s_add_u32 s33, s33, s36
    s_and_b32 s33, s33, 3
    s_cselect_b32 s42, 99, s42
    s_cselect_b32 s39, 0, 2
    s_mov_b32 s5, 0
    s_sub_u32 s37, s42, 19
    s_mul_i32 s37, s37, 163
    s_lshr_b32 s37, s37, 8
    s_add_u32 s37, s37, 6
    s_mov_b32 s48, 4
    s_mov_b32 s49, 99
    s_mov_b32 s38, 3
    v_add_u32 v75, 8192, v6
    s_waitcnt lgkmcnt(0)
    s_add_u32 s19, s34, 0x40000000
    s_barrier
    s_waitcnt vmcnt(4)
    buffer_load_dwordx4 v2, s[8:11], s16 offen offset:3072 nt lds
    s_add_u32 m0, m0, 4096
    s_waitcnt vmcnt(4)
    buffer_load_dwordx4 v3, s[8:11], s16 offen nt lds
    s_waitcnt vmcnt(4)
    buffer_load_dwordx4 v3, s[8:11], s16 offen offset:1024 nt lds
    s_waitcnt vmcnt(4)
    buffer_load_dwordx4 v3, s[8:11], s16 offen offset:2048 nt lds
    s_waitcnt vmcnt(4)
    buffer_load_dwordx4 v3, s[8:11], s16 offen offset:3072 nt lds
    s_add_u32 m0, m0, 4096
    s_waitcnt vmcnt(4)
    buffer_load_dwordx4 v4, s[8:11], s16 offen nt lds
    s_waitcnt vmcnt(4)
    buffer_load_dwordx4 v4, s[8:11], s16 offen offset:1024 nt lds
    s_waitcnt vmcnt(4)
    buffer_load_dwordx4 v4, s[8:11], s16 offen offset:2048 nt lds
    s_waitcnt vmcnt(4)
    buffer_load_dwordx4 v4, s[8:11], s16 offen offset:3072 nt lds
    s_add_u32 m0, m0, 4096
    s_add_u32 s14, s14, 0x20000
    s_and_b32 s16, s14, 0xe0000
    s_lshr_b32 s27, s14, 6
    s_and_b32 s27, s27, 0x4000
    s_or_b32 s16, s16, s27
    s_xor_b32 s16, s16, s15
    s_waitcnt vmcnt(4)
    buffer_load_dwordx4 v1, s[8:11], s16 offen nt lds
    s_waitcnt vmcnt(4)
    buffer_load_dwordx4 v1, s[8:11], s16 offen offset:1024 nt lds
    s_waitcnt vmcnt(4)
    buffer_load_dwordx4 v1, s[8:11], s16 offen offset:2048 nt lds
    s_waitcnt vmcnt(4)
    buffer_load_dwordx4 v1, s[8:11], s16 offen offset:3072 nt lds
    s_add_u32 m0, m0, 4096
    s_waitcnt vmcnt(4)
    buffer_load_dwordx4 v2, s[8:11], s16 offen nt lds
    s_waitcnt vmcnt(4)
    buffer_load_dwordx4 v2, s[8:11], s16 offen offset:1024 nt lds
    s_waitcnt vmcnt(4)
    buffer_load_dwordx4 v2, s[8:11], s16 offen offset:2048 nt lds
    s_waitcnt vmcnt(4)
    buffer_load_dwordx4 v2, s[8:11], s16 offen offset:3072 nt lds
    s_add_u32 m0, m0, 4096
    s_waitcnt vmcnt(4)
    buffer_load_dwordx4 v3, s[8:11], s16 offen nt lds
    s_waitcnt vmcnt(4)
    buffer_load_dwordx4 v3, s[8:11], s16 offen offset:1024 nt lds
    s_waitcnt vmcnt(4)
    buffer_load_dwordx4 v3, s[8:11], s16 offen offset:2048 nt lds
    s_waitcnt vmcnt(4)
    buffer_load_dwordx4 v3, s[8:11], s16 offen offset:3072 nt lds
    s_add_u32 m0, m0, 4096
    s_waitcnt vmcnt(4)
    buffer_load_dwordx4 v4, s[8:11], s16 offen nt lds
    s_waitcnt vmcnt(4)
    buffer_load_dwordx4 v4, s[8:11], s16 offen offset:1024 nt lds
    s_waitcnt vmcnt(4)
    buffer_load_dwordx4 v4, s[8:11], s16 offen offset:2048 nt lds
    s_waitcnt vmcnt(4)
    buffer_load_dwordx4 v4, s[8:11], s16 offen offset:3072 nt lds
    s_add_u32 m0, m0, 4096
    s_add_u32 s14, s14, 0x20000
    s_and_b32 s16, s14, 0xe0000
    s_lshr_b32 s27, s14, 6
    s_and_b32 s27, s27, 0x4000
    s_or_b32 s16, s16, s27
    s_xor_b32 s16, s16, s15
    s_waitcnt vmcnt(4)
    buffer_load_dwordx4 v[128:131], v1, s[8:11], s16 offen nt
    s_waitcnt vmcnt(4)
    buffer_load_dwordx4 v[132:135], v1, s[8:11], s16 offen offset:1024 nt
    s_waitcnt vmcnt(4)
    buffer_load_dwordx4 v[136:139], v1, s[8:11], s16 offen offset:2048 nt
    s_waitcnt vmcnt(4)
    buffer_load_dwordx4 v[140:143], v1, s[8:11], s16 offen offset:3072 nt
    s_waitcnt vmcnt(4)
    buffer_load_dwordx4 v[144:147], v2, s[8:11], s16 offen nt
    s_waitcnt vmcnt(4)
    buffer_load_dwordx4 v[148:151], v2, s[8:11], s16 offen offset:1024 nt
    s_waitcnt vmcnt(4)
    buffer_load_dwordx4 v[152:155], v2, s[8:11], s16 offen offset:2048 nt
    s_waitcnt vmcnt(4)
    buffer_load_dwordx4 v[156:159], v2, s[8:11], s16 offen offset:3072 nt
    s_waitcnt vmcnt(4)
    buffer_load_dwordx4 v[160:163], v3, s[8:11], s16 offen nt
    s_waitcnt vmcnt(4)
    buffer_load_dwordx4 v[164:167], v3, s[8:11], s16 offen offset:1024 nt
    s_waitcnt vmcnt(4)
    buffer_load_dwordx4 v[168:171], v3, s[8:11], s16 offen offset:2048 nt
    s_waitcnt vmcnt(4)
    buffer_load_dwordx4 v[172:175], v3, s[8:11], s16 offen offset:3072 nt
    s_waitcnt vmcnt(4)
    buffer_load_dwordx4 v[176:179], v4, s[8:11], s16 offen nt
    s_waitcnt vmcnt(4)
    buffer_load_dwordx4 v[180:183], v4, s[8:11], s16 offen offset:1024 nt
    s_waitcnt vmcnt(4)
    buffer_load_dwordx4 v[184:187], v4, s[8:11], s16 offen offset:2048 nt
    s_waitcnt vmcnt(4)
    buffer_load_dwordx4 v[188:191], v4, s[8:11], s16 offen offset:3072 nt
    s_add_u32 s14, s14, 0x20000
    s_and_b32 s16, s14, 0xe0000
    s_lshr_b32 s27, s14, 6
    s_and_b32 s27, s27, 0x4000
    s_or_b32 s16, s16, s27
    s_xor_b32 s16, s16, s15
    s_waitcnt vmcnt(4)
    buffer_load_dwordx4 v[192:195], v1, s[8:11], s16 offen nt
    s_waitcnt vmcnt(4)
    buffer_load_dwordx4 v[196:199], v1, s[8:11], s16 offen offset:1024 nt
    s_waitcnt vmcnt(4)
    buffer_load_dwordx4 v[200:203], v1, s[8:11], s16 offen offset:2048 nt
    s_waitcnt vmcnt(4)
    buffer_load_dwordx4 v[204:207], v1, s[8:11], s16 offen offset:3072 nt
    s_waitcnt vmcnt(4)
    buffer_load_dwordx4 v[208:211], v2, s[8:11], s16 offen nt
    s_waitcnt vmcnt(4)
    buffer_load_dwordx4 v[212:215], v2, s[8:11], s16 offen offset:1024 nt
    s_waitcnt vmcnt(4)
    buffer_load_dwordx4 v[216:219], v2, s[8:11], s16 offen offset:2048 nt
    s_waitcnt vmcnt(4)
    buffer_load_dwordx4 v[220:223], v2, s[8:11], s16 offen offset:3072 nt
    s_waitcnt vmcnt(4)
    buffer_load_dwordx4 v[224:227], v3, s[8:11], s16 offen nt
    s_waitcnt vmcnt(4)
    buffer_load_dwordx4 v[228:231], v3, s[8:11], s16 offen offset:1024 nt
    s_waitcnt vmcnt(4)
    buffer_load_dwordx4 v[232:235], v3, s[8:11], s16 offen offset:2048 nt
    s_waitcnt vmcnt(4)
    buffer_load_dwordx4 v[236:239], v3, s[8:11], s16 offen offset:3072 nt
    s_waitcnt vmcnt(4)
    buffer_load_dwordx4 v[240:243], v4, s[8:11], s16 offen nt
    s_waitcnt vmcnt(4)
    buffer_load_dwordx4 v[244:247], v4, s[8:11], s16 offen offset:1024 nt
    s_waitcnt vmcnt(4)
    buffer_load_dwordx4 v[248:251], v4, s[8:11], s16 offen offset:2048 nt
    s_waitcnt vmcnt(4)
    buffer_load_dwordx4 v[252:255], v4, s[8:11], s16 offen offset:3072 nt
    s_add_u32 s14, s14, 0x20000
    s_and_b32 s16, s14, 0xe0000
    s_lshr_b32 s27, s14, 6
    s_and_b32 s27, s27, 0x4000
    s_or_b32 s16, s16, s27
    s_xor_b32 s16, s16, s15
L_qwait:
    s_waitcnt lgkmcnt(0)
    ds_read_b128 v[16:19], v56 offset:144
    ds_read_b128 v[80:83], v6 offset:0
    ds_read_b128 v[84:87], v6 offset:16
    ds_read_b128 v[88:91], v6 offset:512
    ds_read_b128 v[92:95], v6 offset:528
    ds_read_b128 v[96:99], v6 offset:1024
    ds_read_b128 v[100:103], v6 offset:1040
    ds_read_b128 v[104:107], v6 offset:1536
    ds_read_b128 v[108:111], v6 offset:1552
    s_waitcnt lgkmcnt(8)
    v_min_u32 v16, v16, v17
    v_min3_u32 v16, v16, v18, v19
    s_nop 0
    v_readfirstlane_b32 s33, v16
    s_nop 0
    s_cmp_eq_u32 s33, 0
    s_cbranch_scc1 L_qwait
    s_waitcnt lgkmcnt(4)
    v_add_f32 v80, v80, v88
    v_add_f32 v81, v81, v89
    v_add_f32 v82, v82, v90
    v_add_f32 v83, v83, v91
    v_add_f32 v84, v84, v92
    v_add_f32 v85, v85, v93
    v_add_f32 v86, v86, v94
    v_add_f32 v87, v87, v95
    s_waitcnt lgkmcnt(0)
    v_add_f32 v96, v96, v104
    v_add_f32 v97, v97, v105
    v_add_f32 v98, v98, v106
    v_add_f32 v99, v99, v107
    v_add_f32 v100, v100, v108
    v_add_f32 v101, v101, v109
    v_add_f32 v102, v102, v110
    v_add_f32 v103, v103, v111
    v_add_f32 v80, v80, v96
    v_add_f32 v81, v81, v97
    v_add_f32 v82, v82, v98
    v_add_f32 v83, v83, v99
    v_add_f32 v84, v84, v100
    v_add_f32 v85, v85, v101
    v_add_f32 v86, v86, v102
    v_add_f32 v87, v87, v103
    v_cvt_pk_bf16_f32 v8, v80, v81
    v_cvt_pk_bf16_f32 v9, v82, v83
    v_cvt_pk_bf16_f32 v10, v84, v85
    v_cvt_pk_bf16_f32 v11, v86, v87
    v_dot2_f32_bf16 v16, v128, v8, 0
    v_dot2_f32_bf16 v16, v129, v9, v16
    v_dot2_f32_bf16 v16, v130, v10, v16
    v_dot2_f32_bf16 v16, v131, v11, v16
    s_waitcnt vmcnt(4)
    buffer_load_dwordx4 v[128:131], v1, s[8:11], s16 offen nt
    v_dot2_f32_bf16 v17, v132, v8, 0
    v_dot2_f32_bf16 v17, v133, v9, v17
    v_dot2_f32_bf16 v17, v134, v10, v17
    v_dot2_f32_bf16 v17, v135, v11, v17
    v_dot2_f32_bf16 v18, v136, v8, 0
    v_dot2_f32_bf16 v18, v137, v9, v18
    v_dot2_f32_bf16 v18, v138, v10, v18
    v_dot2_f32_bf16 v18, v139, v11, v18
    v_dot2_f32_bf16 v19, v140, v8, 0
    v_dot2_f32_bf16 v19, v141, v9, v19
    v_dot2_f32_bf16 v19, v142, v10, v19
    v_dot2_f32_bf16 v19, v143, v11, v19
    v_dot2_f32_bf16 v20, v144, v8, 0
    v_dot2_f32_bf16 v20, v145, v9, v20
    v_dot2_f32_bf16 v20, v146, v10, v20
    v_dot2_f32_bf16 v20, v147, v11, v20
    s_waitcnt vmcnt(4)
    buffer_load_dwordx4 v[132:135], v1, s[8:11], s16 offen offset:1024 nt
    v_dot2_f32_bf16 v21, v148, v8, 0
    v_dot2_f32_bf16 v21, v149, v9, v21
    v_dot2_f32_bf16 v21, v150, v10, v21
    v_dot2_f32_bf16 v21, v151, v11, v21
    v_dot2_f32_bf16 v22, v152, v8, 0
    v_dot2_f32_bf16 v22, v153, v9, v22
    v_dot2_f32_bf16 v22, v154, v10, v22
    v_dot2_f32_bf16 v22, v155, v11, v22
    v_dot2_f32_bf16 v23, v156, v8, 0
    v_dot2_f32_bf16 v23, v157, v9, v23
    v_dot2_f32_bf16 v23, v158, v10, v23
    v_dot2_f32_bf16 v23, v159, v11, v23
    v_dot2_f32_bf16 v24, v160, v8, 0
    v_dot2_f32_bf16 v24, v161, v9, v24
    v_dot2_f32_bf16 v24, v162, v10, v24
    v_dot2_f32_bf16 v24, v163, v11, v24
    v_dot2_f32_bf16 v25, v164, v8, 0
    v_dot2_f32_bf16 v25, v165, v9, v25
    v_dot2_f32_bf16 v25, v166, v10, v25
    v_dot2_f32_bf16 v25, v167, v11, v25
    v_add_f32_dpp v16, v16, v16 row_ror:8 row_mask:0xf bank_mask:0x3
    v_add_f32_dpp v16, v24, v24 row_ror:8 row_mask:0xf bank_mask:0xc
    s_waitcnt vmcnt(4)
    buffer_load_dwordx4 v[136:139], v1, s[8:11], s16 offen offset:2048 nt
    v_dot2_f32_bf16 v26, v168, v8, 0
    v_dot2_f32_bf16 v26, v169, v9, v26
    v_dot2_f32_bf16 v26, v170, v10, v26
    v_dot2_f32_bf16 v26, v171, v11, v26
    v_add_f32_dpp v17, v17, v17 row_ror:8 row_mask:0xf bank_mask:0x3
    v_add_f32_dpp v17, v25, v25 row_ror:8 row_mask:0xf bank_mask:0xc
    v_dot2_f32_bf16 v27, v172, v8, 0
    v_dot2_f32_bf16 v27, v173, v9, v27
    v_dot2_f32_bf16 v27, v174, v10, v27
    v_dot2_f32_bf16 v27, v175, v11, v27
    v_add_f32_dpp v18, v18, v18 row_ror:8 row_mask:0xf bank_mask:0x3
    v_add_f32_dpp v18, v26, v26 row_ror:8 row_mask:0xf bank_mask:0xc
    v_dot2_f32_bf16 v28, v176, v8, 0
    v_dot2_f32_bf16 v28, v177, v9, v28
    v_dot2_f32_bf16 v28, v178, v10, v28
    v_dot2_f32_bf16 v28, v179, v11, v28
    v_add_f32_dpp v19, v19, v19 row_ror:8 row_mask:0xf bank_mask:0x3
    v_add_f32_dpp v19, v27, v27 row_ror:8 row_mask:0xf bank_mask:0xc
    v_dot2_f32_bf16 v29, v180, v8, 0
    v_dot2_f32_bf16 v29, v181, v9, v29
    v_dot2_f32_bf16 v29, v182, v10, v29
    v_dot2_f32_bf16 v29, v183, v11, v29
    v_add_f32_dpp v20, v20, v20 row_ror:8 row_mask:0xf bank_mask:0x3
    v_add_f32_dpp v20, v28, v28 row_ror:8 row_mask:0xf bank_mask:0xc
    s_waitcnt vmcnt(4)
    buffer_load_dwordx4 v[140:143], v1, s[8:11], s16 offen offset:3072 nt
    v_dot2_f32_bf16 v30, v184, v8, 0
    v_dot2_f32_bf16 v30, v185, v9, v30
    v_dot2_f32_bf16 v30, v186, v10, v30
    v_dot2_f32_bf16 v30, v187, v11, v30
    v_add_f32_dpp v21, v21, v21 row_ror:8 row_mask:0xf bank_mask:0x3
    v_add_f32_dpp v21, v29, v29 row_ror:8 row_mask:0xf bank_mask:0xc
    v_dot2_f32_bf16 v31, v188, v8, 0
    v_dot2_f32_bf16 v31, v189, v9, v31
    v_dot2_f32_bf16 v31, v190, v10, v31
    v_dot2_f32_bf16 v31, v191, v11, v31
    v_add_f32_dpp v22, v22, v22 row_ror:8 row_mask:0xf bank_mask:0x3
    v_add_f32_dpp v22, v30, v30 row_ror:8 row_mask:0xf bank_mask:0xc
    v_add_f32_dpp v16, v16, v16 row_half_mirror row_mask:0xf bank_mask:0x5
    v_add_f32_dpp v16, v20, v20 row_half_mirror row_mask:0xf bank_mask:0xa
    v_add_f32_dpp v17, v17, v17 row_half_mirror row_mask:0xf bank_mask:0x5
    v_add_f32_dpp v17, v21, v21 row_half_mirror row_mask:0xf bank_mask:0xa
    v_add_f32_dpp v23, v23, v23 row_ror:8 row_mask:0xf bank_mask:0x3
    v_add_f32_dpp v23, v31, v31 row_ror:8 row_mask:0xf bank_mask:0xc
    v_add_f32_dpp v18, v18, v18 row_half_mirror row_mask:0xf bank_mask:0x5
    v_add_f32_dpp v18, v22, v22 row_half_mirror row_mask:0xf bank_mask:0xa
    v_add_f32_dpp v19, v19, v19 row_half_mirror row_mask:0xf bank_mask:0x5
    v_add_f32_dpp v19, v23, v23 row_half_mirror row_mask:0xf bank_mask:0xa
    v_add_f32_dpp v16, v16, v16 quad_perm:[2,3,0,1] row_mask:0xf bank_mask:0xf
    v_add_f32_dpp v17, v17, v17 quad_perm:[2,3,0,1] row_mask:0xf bank_mask:0xf
    v_add_f32_dpp v18, v18, v18 quad_perm:[2,3,0,1] row_mask:0xf bank_mask:0xf
    v_add_f32_dpp v19, v19, v19 quad_perm:[2,3,0,1] row_mask:0xf bank_mask:0xf
    v_cndmask_b32 v16, v16, v18, s[20:21]
    v_cndmask_b32 v17, v17, v19, s[20:21]
    s_nop 0
    v_add_f32_dpp v16, v16, v16 quad_perm:[1,0,3,2] row_mask:0xf bank_mask:0xf
    v_add_f32_dpp v17, v17, v17 quad_perm:[1,0,3,2] row_mask:0xf bank_mask:0xf
    v_cndmask_b32 v16, v16, v17, s[22:23]
    v_cvt_pk_bf16_f32 v54, v16, v16
    v_and_b32 v54, s26, v54
    v_mul_f32 v54, s24, v54
    v_cvt_pk_bf16_f32 v54, v54, v54
    v_and_b32 v54, s26, v54
    v_dot2_f32_bf16 v16, v192, v8, 0
    v_dot2_f32_bf16 v16, v193, v9, v16
    v_dot2_f32_bf16 v16, v194, v10, v16
    v_dot2_f32_bf16 v16, v195, v11, v16
    s_waitcnt vmcnt(4)
    buffer_load_dwordx4 v[144:147], v2, s[8:11], s16 offen nt
    v_dot2_f32_bf16 v17, v196, v8, 0
    v_dot2_f32_bf16 v17, v197, v9, v17
    v_dot2_f32_bf16 v17, v198, v10, v17
    v_dot2_f32_bf16 v17, v199, v11, v17
    v_dot2_f32_bf16 v18, v200, v8, 0
    v_dot2_f32_bf16 v18, v201, v9, v18
    v_dot2_f32_bf16 v18, v202, v10, v18
    v_dot2_f32_bf16 v18, v203, v11, v18
    v_dot2_f32_bf16 v19, v204, v8, 0
    v_dot2_f32_bf16 v19, v205, v9, v19
    v_dot2_f32_bf16 v19, v206, v10, v19
    v_dot2_f32_bf16 v19, v207, v11, v19
    v_dot2_f32_bf16 v20, v208, v8, 0
    v_dot2_f32_bf16 v20, v209, v9, v20
    v_dot2_f32_bf16 v20, v210, v10, v20
    v_dot2_f32_bf16 v20, v211, v11, v20
    s_waitcnt vmcnt(4)
    buffer_load_dwordx4 v[148:151], v2, s[8:11], s16 offen offset:1024 nt
    v_dot2_f32_bf16 v21, v212, v8, 0
    v_dot2_f32_bf16 v21, v213, v9, v21
    v_dot2_f32_bf16 v21, v214, v10, v21
    v_dot2_f32_bf16 v21, v215, v11, v21
    v_dot2_f32_bf16 v22, v216, v8, 0
    v_dot2_f32_bf16 v22, v217, v9, v22
    v_dot2_f32_bf16 v22, v218, v10, v22
    v_dot2_f32_bf16 v22, v219, v11, v22
    v_dot2_f32_bf16 v23, v220, v8, 0
    v_dot2_f32_bf16 v23, v221, v9, v23
    v_dot2_f32_bf16 v23, v222, v10, v23
    v_dot2_f32_bf16 v23, v223, v11, v23
    v_dot2_f32_bf16 v24, v224, v8, 0
    v_dot2_f32_bf16 v24, v225, v9, v24
    v_dot2_f32_bf16 v24, v226, v10, v24
    v_dot2_f32_bf16 v24, v227, v11, v24
    v_dot2_f32_bf16 v25, v228, v8, 0
    v_dot2_f32_bf16 v25, v229, v9, v25
    v_dot2_f32_bf16 v25, v230, v10, v25
    v_dot2_f32_bf16 v25, v231, v11, v25
    v_add_f32_dpp v16, v16, v16 row_ror:8 row_mask:0xf bank_mask:0x3
    v_add_f32_dpp v16, v24, v24 row_ror:8 row_mask:0xf bank_mask:0xc
    s_waitcnt vmcnt(4)
    buffer_load_dwordx4 v[152:155], v2, s[8:11], s16 offen offset:2048 nt
    s_memrealtime s[34:35]
    v_dot2_f32_bf16 v26, v232, v8, 0
    v_dot2_f32_bf16 v26, v233, v9, v26
    v_dot2_f32_bf16 v26, v234, v10, v26
    v_dot2_f32_bf16 v26, v235, v11, v26
    v_add_f32_dpp v17, v17, v17 row_ror:8 row_mask:0xf bank_mask:0x3
    v_add_f32_dpp v17, v25, v25 row_ror:8 row_mask:0xf bank_mask:0xc
    v_dot2_f32_bf16 v27, v236, v8, 0
    v_dot2_f32_bf16 v27, v237, v9, v27
    v_dot2_f32_bf16 v27, v238, v10, v27
    v_dot2_f32_bf16 v27, v239, v11, v27
    v_add_f32_dpp v18, v18, v18 row_ror:8 row_mask:0xf bank_mask:0x3
    v_add_f32_dpp v18, v26, v26 row_ror:8 row_mask:0xf bank_mask:0xc
    v_dot2_f32_bf16 v28, v240, v8, 0
    v_dot2_f32_bf16 v28, v241, v9, v28
    v_dot2_f32_bf16 v28, v242, v10, v28
    v_dot2_f32_bf16 v28, v243, v11, v28
    v_add_f32_dpp v19, v19, v19 row_ror:8 row_mask:0xf bank_mask:0x3
    v_add_f32_dpp v19, v27, v27 row_ror:8 row_mask:0xf bank_mask:0xc
    v_dot2_f32_bf16 v29, v244, v8, 0
    v_dot2_f32_bf16 v29, v245, v9, v29
    v_dot2_f32_bf16 v29, v246, v10, v29
    v_dot2_f32_bf16 v29, v247, v11, v29
    v_add_f32_dpp v20, v20, v20 row_ror:8 row_mask:0xf bank_mask:0x3
    v_add_f32_dpp v20, v28, v28 row_ror:8 row_mask:0xf bank_mask:0xc
    v_dot2_f32_bf16 v30, v248, v8, 0
    v_dot2_f32_bf16 v30, v249, v9, v30
    v_dot2_f32_bf16 v30, v250, v10, v30
    v_dot2_f32_bf16 v30, v251, v11, v30
    v_add_f32_dpp v21, v21, v21 row_ror:8 row_mask:0xf bank_mask:0x3
    v_add_f32_dpp v21, v29, v29 row_ror:8 row_mask:0xf bank_mask:0xc
    v_dot2_f32_bf16 v31, v252, v8, 0
    v_dot2_f32_bf16 v31, v253, v9, v31
    v_dot2_f32_bf16 v31, v254, v10, v31
    v_dot2_f32_bf16 v31, v255, v11, v31
    v_add_f32_dpp v22, v22, v22 row_ror:8 row_mask:0xf bank_mask:0x3
    v_add_f32_dpp v22, v30, v30 row_ror:8 row_mask:0xf bank_mask:0xc
    s_mov_b32 s18, 2
.p2align 6
L_kloop:
    s_waitcnt lgkmcnt(0)
    s_add_u32 s32, s34, s31
    v_mov_b32 v63, s18
    v_mov_b32 v62, s32
    ds_write_b64 v57, v[62:63] offset:4272
    s_add_u32 s32, s34, s31
    s_sub_u32 s32, s32, s19
    s_cmp_gt_i32 s32, 0
    s_cselect_b64 vcc, -1, 0
    s_cselect_b32 s31, 27, 0
    s_add_u32 s19, s19, s30
    s_add_u32 s32, s32, s40
    s_cmp_lt_u32 s32, 2000
    s_cselect_b32 s31, -13, s31
    s_cmp_lt_i32 s31, 0
    s_cbranch_scc0 L_ew0
    s_waitcnt vmcnt(3)
L_ew0:
    s_waitcnt vmcnt(6)
    s_cbranch_vccnz L_ev1
    s_waitcnt vmcnt(4)
L_ev1:
    buffer_load_dwordx4 v[156:159], v2, s[8:11], s16 offen offset:3072 nt
    v_add_f32_dpp v16, v16, v16 row_half_mirror row_mask:0xf bank_mask:0x5
    v_add_f32_dpp v16, v20, v20 row_half_mirror row_mask:0xf bank_mask:0xa
    v_add_f32_dpp v17, v17, v17 row_half_mirror row_mask:0xf bank_mask:0x5
    v_add_f32_dpp v17, v21, v21 row_half_mirror row_mask:0xf bank_mask:0xa
    v_add_f32_dpp v23, v23, v23 row_ror:8 row_mask:0xf bank_mask:0x3
    v_add_f32_dpp v23, v31, v31 row_ror:8 row_mask:0xf bank_mask:0xc
    v_add_f32_dpp v18, v18, v18 row_half_mirror row_mask:0xf bank_mask:0x5
    v_add_f32_dpp v18, v22, v22 row_half_mirror row_mask:0xf bank_mask:0xa
    v_add_f32_dpp v19, v19, v19 row_half_mirror row_mask:0xf bank_mask:0x5
    v_add_f32_dpp v19, v23, v23 row_half_mirror row_mask:0xf bank_mask:0xa
    v_add_f32_dpp v16, v16, v16 quad_perm:[2,3,0,1] row_mask:0xf bank_mask:0xf
    v_add_f32_dpp v17, v17, v17 quad_perm:[2,3,0,1] row_mask:0xf bank_mask:0xf
    v_add_f32_dpp v18, v18, v18 quad_perm:[2,3,0,1] row_mask:0xf bank_mask:0xf
    s_cmp_lt_i32 s31, 0
    s_cbranch_scc0 L_ew1
    s_waitcnt vmcnt(3)
L_ew1:
    s_waitcnt vmcnt(6)
    s_cbranch_vccnz L_ev2
    s_waitcnt vmcnt(4)
L_ev2:
    buffer_load_dwordx4 v[160:163], v3, s[8:11], s16 offen nt
    v_add_f32_dpp v19, v19, v19 quad_perm:[2,3,0,1] row_mask:0xf bank_mask:0xf
    v_cndmask_b32 v16, v16, v18, s[20:21]
    v_cndmask_b32 v17, v17, v19, s[20:21]
    s_nop 0
    v_add_f32_dpp v16, v16, v16 quad_perm:[1,0,3,2] row_mask:0xf bank_mask:0xf
    v_add_f32_dpp v17, v17, v17 quad_perm:[1,0,3,2] row_mask:0xf bank_mask:0xf
    v_cndmask_b32 v16, v16, v17, s[22:23]
    v_cvt_pk_bf16_f32 v55, v16, v16
    v_and_b32 v55, s26, v55
    v_mul_f32 v55, s24, v55
    v_cvt_pk_bf16_f32 v55, v55, v55
    v_and_b32 v55, s26, v55
    s_cmp_lt_i32 s31, 0
    s_cbranch_scc0 L_ew2
    s_waitcnt vmcnt(3)
L_ew2:
    s_waitcnt vmcnt(6)
    s_cbranch_vccnz L_ev3
    s_waitcnt vmcnt(4)
L_ev3:
    buffer_load_dwordx4 v[164:167], v3, s[8:11], s16 offen offset:1024 nt
    s_add_u32 s38, s38, 1
    s_sub_u32 s51, s38, s49
    s_cmp_le_u32 s51, 2
    s_cbranch_scc0 L_xr1
    s_cmp_eq_u32 s51, 1
    s_cbranch_scc0 L_xa1
    v_lshrrev_b32 v76, 16, v55
    s_branch L_xr1
L_xa1:
    v_swap_b32 v8, v112
    v_swap_b32 v9, v113
    v_swap_b32 v10, v114
    v_swap_b32 v11, v115
    s_cmp_eq_u32 s51, 0
    s_cbranch_scc1 L_xr1
    v_or_b32 v76, v76, v55
    v_mov_b32 v127, 1
    ds_write_b32 v125, v76 offset:10752
    ds_write_b32 v124, v127 offset:4320
L_xr1:
    v_dot2_f32_bf16 v16, v128, v8, 0
    v_dot2_f32_bf16 v16, v129, v9, v16
    v_dot2_f32_bf16 v16, v130, v10, v16
    v_dot2_f32_bf16 v16, v131, v11, v16
    v_dot2_f32_bf16 v17, v132, v8, 0
    v_dot2_f32_bf16 v17, v133, v9, v17
    v_dot2_f32_bf16 v17, v134, v10, v17
    v_dot2_f32_bf16 v17, v135, v11, v17
    s_cmp_lt_i32 s31, 0
    s_cbranch_scc0 L_ew3
    s_waitcnt vmcnt(3)
L_ew3:
    s_waitcnt vmcnt(6)
    s_cbranch_vccnz L_ev4
    s_waitcnt vmcnt(4)
L_ev4:
    buffer_load_dwordx4 v[168:171], v3, s[8:11], s16 offen offset:2048 nt
    s_memrealtime s[34:35]
    v_dot2_f32_bf16 v18, v136, v8, 0
    v_dot2_f32_bf16 v18, v137, v9, v18
    v_dot2_f32_bf16 v18, v138, v10, v18
    v_dot2_f32_bf16 v18, v139, v11, v18
    v_mov_b32 v40, v42
    v_mov_b32 v41, v43
    v_dot2_f32_bf16 v19, v140, v8, 0
    v_dot2_f32_bf16 v19, v141, v9, v19
    v_dot2_f32_bf16 v19, v142, v10, v19
    v_dot2_f32_bf16 v19, v143, v11, v19
    v_mov_b32 v42, v44
    v_mov_b32 v43, v45
    s_waitcnt lgkmcnt(0)
    s_add_u32 s32, s34, s31
    s_sub_u32 s32, s32, s19
    s_cmp_gt_i32 s32, 0
    s_cselect_b64 vcc, -1, 0
    s_cselect_b32 s31, 27, 0
    s_add_u32 s19, s19, s30
    s_add_u32 s32, s32, s40
    s_cmp_lt_u32 s32, 2000
    s_cselect_b32 s31, -13, s31
    s_cmp_lt_i32 s31, 0
    s_cbranch_scc0 L_ew4
    s_waitcnt vmcnt(3)
L_ew4:
    s_waitcnt vmcnt(6)
    s_cbranch_vccnz L_ev5
    s_waitcnt vmcnt(4)
L_ev5:
    buffer_load_dwordx4 v[172:175], v3, s[8:11], s16 offen offset:3072 nt
    v_dot2_f32_bf16 v20, v144, v8, 0
    v_dot2_f32_bf16 v20, v145, v9, v20
    v_dot2_f32_bf16 v20, v146, v10, v20
    v_dot2_f32_bf16 v20, v147, v11, v20
    v_mov_b32 v44, v46
    v_mov_b32 v45, v47
    s_cmp_lt_i32 s31, 0
    s_cbranch_scc0 L_ew5
    s_waitcnt vmcnt(3)
L_ew5:
    s_waitcnt vmcnt(6)
    s_cbranch_vccnz L_ev6
    s_waitcnt vmcnt(4)
L_ev6:
    buffer_load_dwordx4 v[176:179], v4, s[8:11], s16 offen nt
    v_dot2_f32_bf16 v21, v148, v8, 0
    v_dot2_f32_bf16 v21, v149, v9, v21
    v_dot2_f32_bf16 v21, v150, v10, v21
    v_dot2_f32_bf16 v21, v151, v11, v21
    v_mov_b32 v46, v48
    v_mov_b32 v47, v49
    s_cmp_lt_i32 s31, 0
    s_cbranch_scc0 L_ew6
    s_waitcnt vmcnt(3)
L_ew6:
    s_waitcnt vmcnt(6)
    s_cbranch_vccnz L_ev7
    s_waitcnt vmcnt(4)
L_ev7:
    buffer_load_dwordx4 v[180:183], v4, s[8:11], s16 offen offset:1024 nt
    v_dot2_f32_bf16 v22, v152, v8, 0
    v_dot2_f32_bf16 v22, v153, v9, v22
    v_dot2_f32_bf16 v22, v154, v10, v22
    v_dot2_f32_bf16 v22, v155, v11, v22
    v_mov_b32 v48, v50
    v_mov_b32 v49, v51
    s_cmp_lt_i32 s31, 0
    s_cbranch_scc0 L_ew7
    s_waitcnt vmcnt(3)
L_ew7:
    s_waitcnt vmcnt(6)
    s_cbranch_vccnz L_ev8
    s_waitcnt vmcnt(4)
L_ev8:
    buffer_load_dwordx4 v[184:187], v4, s[8:11], s16 offen offset:2048 nt
    s_memrealtime s[34:35]
    v_dot2_f32_bf16 v23, v156, v8, 0
    v_dot2_f32_bf16 v23, v157, v9, v23
    v_dot2_f32_bf16 v23, v158, v10, v23
    v_dot2_f32_bf16 v23, v159, v11, v23
    v_mov_b32 v50, v52
    v_mov_b32 v51, v53
    s_waitcnt lgkmcnt(0)
    s_add_u32 s32, s34, s31
    s_sub_u32 s32, s32, s19
    s_cmp_gt_i32 s32, 0
    s_cselect_b64 vcc, -1, 0
    s_cselect_b32 s31, 27, 0
    s_add_u32 s19, s19, s30
    s_add_u32 s32, s32, s40
    s_cmp_lt_u32 s32, 2000
    s_cselect_b32 s31, -13, s31
    s_cmp_lt_i32 s31, 0
    s_cbranch_scc0 L_ew8
    s_waitcnt vmcnt(3)
L_ew8:
    s_waitcnt vmcnt(6)
    s_cbranch_vccnz L_ev9
    s_waitcnt vmcnt(4)
L_ev9:
    buffer_load_dwordx4 v[188:191], v4, s[8:11], s16 offen offset:3072 nt
    s_add_u32 s14, s14, 0x20000
    s_and_b32 s16, s14, 0xe0000
    s_lshr_b32 s27, s14, 6
    s_and_b32 s27, s27, 0x4000
    s_or_b32 s16, s16, s27
    s_xor_b32 s16, s16, s15
    s_add_u32 s48, s48, 1
    s_sub_u32 s27, s48, s49
    s_cmp_lt_u32 s27, 2
    s_cselect_b32 s27, 0x422000, 0
    s_xor_b32 s16, s16, s27
    v_dot2_f32_bf16 v24, v160, v8, 0
    v_dot2_f32_bf16 v24, v161, v9, v24
    v_dot2_f32_bf16 v24, v162, v10, v24
    v_dot2_f32_bf16 v24, v163, v11, v24
    v_mov_b32 v52, v54
    v_mov_b32 v53, v55
    s_cmp_lt_i32 s31, 0
    s_cbranch_scc0 L_ew9
    s_waitcnt vmcnt(3)
L_ew9:
    s_waitcnt vmcnt(6)
    s_cbranch_vccnz L_ev10
    s_waitcnt vmcnt(4)
L_ev10:
    buffer_load_dwordx4 v[192:195], v1, s[8:11], s16 offen nt
    v_dot2_f32_bf16 v25, v164, v8, 0
    v_dot2_f32_bf16 v25, v165, v9, v25
    v_dot2_f32_bf16 v25, v166, v10, v25
    v_dot2_f32_bf16 v25, v167, v11, v25
    v_add_f32_dpp v16, v16, v16 row_ror:8 row_mask:0xf bank_mask:0x3
    v_add_f32_dpp v16, v24, v24 row_ror:8 row_mask:0xf bank_mask:0xc
    s_cmp_lt_i32 s31, 0
    s_cbranch_scc0 L_ew10
    s_waitcnt vmcnt(3)
L_ew10:
    s_waitcnt vmcnt(6)
    s_cbranch_vccnz L_ev11
    s_waitcnt vmcnt(4)
L_ev11:
    buffer_load_dwordx4 v[196:199], v1, s[8:11], s16 offen offset:1024 nt
    v_dot2_f32_bf16 v26, v168, v8, 0
    v_dot2_f32_bf16 v26, v169, v9, v26
    v_dot2_f32_bf16 v26, v170, v10, v26
    v_dot2_f32_bf16 v26, v171, v11, v26
    v_add_f32_dpp v17, v17, v17 row_ror:8 row_mask:0xf bank_mask:0x3
    v_add_f32_dpp v17, v25, v25 row_ror:8 row_mask:0xf bank_mask:0xc
    ds_read_b96 v[58:60], v56 offset:128
    ds_read_b32 v0, v56 offset:140
    s_cmp_lt_i32 s31, 0
    s_cbranch_scc0 L_ew11
    s_waitcnt vmcnt(3)
L_ew11:
    s_waitcnt vmcnt(6)
    s_cbranch_vccnz L_ev12
    s_waitcnt vmcnt(4)
L_ev12:
    buffer_load_dwordx4 v[200:203], v1, s[8:11], s16 offen offset:2048 nt
    s_memrealtime s[34:35]
    v_dot2_f32_bf16 v27, v172, v8, 0
    v_dot2_f32_bf16 v27, v173, v9, v27
    v_dot2_f32_bf16 v27, v174, v10, v27
    v_dot2_f32_bf16 v27, v175, v11, v27
    v_add_f32_dpp v18, v18, v18 row_ror:8 row_mask:0xf bank_mask:0x3
    v_add_f32_dpp v18, v26, v26 row_ror:8 row_mask:0xf bank_mask:0xc
    s_waitcnt lgkmcnt(0)
    v_readfirstlane_b32 s32, v60
    v_readfirstlane_b32 s33, v58
    v_readfirstlane_b32 s36, v59
    v_readfirstlane_b32 s40, v0
    s_cmp_eq_u32 s32, s18
    s_cselect_b32 s19, s33, s19
    s_cselect_b32 s30, s36, s30
    s_add_u32 s32, s34, s31
    s_sub_u32 s32, s32, s19
    s_cmp_gt_i32 s32, 0
    s_cselect_b64 vcc, -1, 0
    s_cselect_b32 s31, 27, 0
    s_add_u32 s19, s19, s30
    s_add_u32 s32, s32, s40
    s_cmp_lt_u32 s32, 2000
    s_cselect_b32 s31, -13, s31
    s_cmp_lt_i32 s31, 0
    s_cbranch_scc0 L_ew12
    s_waitcnt vmcnt(3)
L_ew12:
    s_waitcnt vmcnt(6)
    s_cbranch_vccnz L_ev13
    s_waitcnt vmcnt(4)
L_ev13:
    buffer_load_dwordx4 v[204:207], v1, s[8:11], s16 offen offset:3072 nt
    v_dot2_f32_bf16 v28, v176, v8, 0
    v_dot2_f32_bf16 v28, v177, v9, v28
    v_dot2_f32_bf16 v28, v178, v10, v28
    v_dot2_f32_bf16 v28, v179, v11, v28
    v_add_f32_dpp v19, v19, v19 row_ror:8 row_mask:0xf bank_mask:0x3
    v_add_f32_dpp v19, v27, v27 row_ror:8 row_mask:0xf bank_mask:0xc
    s_cmp_lt_i32 s31, 0
    s_cbranch_scc0 L_ew13
    s_waitcnt vmcnt(3)
L_ew13:
    s_waitcnt vmcnt(6)
    s_cbranch_vccnz L_ev14
    s_waitcnt vmcnt(4)
L_ev14:
    buffer_load_dwordx4 v[208:211], v2, s[8:11], s16 offen nt
    v_dot2_f32_bf16 v29, v180, v8, 0
    v_dot2_f32_bf16 v29, v181, v9, v29
    v_dot2_f32_bf16 v29, v182, v10, v29
    v_dot2_f32_bf16 v29, v183, v11, v29
    v_add_f32_dpp v20, v20, v20 row_ror:8 row_mask:0xf bank_mask:0x3
    v_add_f32_dpp v20, v28, v28 row_ror:8 row_mask:0xf bank_mask:0xc
    s_cmp_lt_i32 s31, 0
    s_cbranch_scc0 L_ew14
    s_waitcnt vmcnt(3)
L_ew14:
    s_waitcnt vmcnt(6)
    s_cbranch_vccnz L_ev15
    s_waitcnt vmcnt(4)
L_ev15:
    buffer_load_dwordx4 v[212:215], v2, s[8:11], s16 offen offset:1024 nt
    v_dot2_f32_bf16 v30, v184, v8, 0
    v_dot2_f32_bf16 v30, v185, v9, v30
    v_dot2_f32_bf16 v30, v186, v10, v30
    v_dot2_f32_bf16 v30, v187, v11, v30
    v_add_f32_dpp v21, v21, v21 row_ror:8 row_mask:0xf bank_mask:0x3
    v_add_f32_dpp v21, v29, v29 row_ror:8 row_mask:0xf bank_mask:0xc
    s_cmp_lt_i32 s31, 0
    s_cbranch_scc0 L_ew15
    s_waitcnt vmcnt(3)
L_ew15:
    s_waitcnt vmcnt(6)
    s_cbranch_vccnz L_ev16
    s_waitcnt vmcnt(4)
L_ev16:
    buffer_load_dwordx4 v[216:219], v2, s[8:11], s16 offen offset:2048 nt
    s_memrealtime s[34:35]
    v_dot2_f32_bf16 v31, v188, v8, 0
    v_dot2_f32_bf16 v31, v189, v9, v31
    v_dot2_f32_bf16 v31, v190, v10, v31
    v_dot2_f32_bf16 v31, v191, v11, v31
    v_add_f32_dpp v22, v22, v22 row_ror:8 row_mask:0xf bank_mask:0x3
    v_add_f32_dpp v22, v30, v30 row_ror:8 row_mask:0xf bank_mask:0xc
    s_waitcnt lgkmcnt(0)
    s_add_u32 s32, s34, s31
    s_sub_u32 s32, s32, s19
    s_cmp_gt_i32 s32, 0
    s_cselect_b64 vcc, -1, 0
    s_cselect_b32 s31, 27, 0
    s_add_u32 s19, s19, s30
    s_add_u32 s32, s32, s40
    s_cmp_lt_u32 s32, 2000
    s_cselect_b32 s31, -13, s31
    s_cmp_lt_i32 s31, 0
    s_cbranch_scc0 L_ew16
    s_waitcnt vmcnt(3)
L_ew16:
    s_waitcnt vmcnt(6)
    s_cbranch_vccnz L_ev17
    s_waitcnt vmcnt(4)
L_ev17:
    buffer_load_dwordx4 v[220:223], v2, s[8:11], s16 offen offset:3072 nt
    v_add_f32_dpp v16, v16, v16 row_half_mirror row_mask:0xf bank_mask:0x5
    v_add_f32_dpp v16, v20, v20 row_half_mirror row_mask:0xf bank_mask:0xa
    v_add_f32_dpp v17, v17, v17 row_half_mirror row_mask:0xf bank_mask:0x5
    v_add_f32_dpp v17, v21, v21 row_half_mirror row_mask:0xf bank_mask:0xa
    v_add_f32_dpp v23, v23, v23 row_ror:8 row_mask:0xf bank_mask:0x3
    v_add_f32_dpp v23, v31, v31 row_ror:8 row_mask:0xf bank_mask:0xc
    v_add_f32_dpp v18, v18, v18 row_half_mirror row_mask:0xf bank_mask:0x5
    v_add_f32_dpp v18, v22, v22 row_half_mirror row_mask:0xf bank_mask:0xa
    v_add_f32_dpp v19, v19, v19 row_half_mirror row_mask:0xf bank_mask:0x5
    v_add_f32_dpp v19, v23, v23 row_half_mirror row_mask:0xf bank_mask:0xa
    v_add_f32_dpp v16, v16, v16 quad_perm:[2,3,0,1] row_mask:0xf bank_mask:0xf
    v_add_f32_dpp v17, v17, v17 quad_perm:[2,3,0,1] row_mask:0xf bank_mask:0xf
    v_add_f32_dpp v18, v18, v18 quad_perm:[2,3,0,1] row_mask:0xf bank_mask:0xf
    s_cmp_lt_i32 s31, 0
    s_cbranch_scc0 L_ew17
    s_waitcnt vmcnt(3)
L_ew17:
    s_waitcnt vmcnt(6)
    s_cbranch_vccnz L_ev18
    s_waitcnt vmcnt(4)
L_ev18:
    buffer_load_dwordx4 v[224:227], v3, s[8:11], s16 offen nt
    v_add_f32_dpp v19, v19, v19 quad_perm:[2,3,0,1] row_mask:0xf bank_mask:0xf
    v_cndmask_b32 v16, v16, v18, s[20:21]
    v_cndmask_b32 v17, v17, v19, s[20:21]
    s_nop 0
    v_add_f32_dpp v16, v16, v16 quad_perm:[1,0,3,2] row_mask:0xf bank_mask:0xf
    v_add_f32_dpp v17, v17, v17 quad_perm:[1,0,3,2] row_mask:0xf bank_mask:0xf
    v_cndmask_b32 v16, v16, v17, s[22:23]
    v_cvt_pk_bf16_f32 v54, v16, v16
    v_and_b32 v54, s26, v54
    v_mul_f32 v54, s24, v54
    v_cvt_pk_bf16_f32 v54, v54, v54
    v_and_b32 v54, s26, v54
    s_cmp_lt_i32 s31, 0
    s_cbranch_scc0 L_ew18
    s_waitcnt vmcnt(3)
L_ew18:
    s_waitcnt vmcnt(6)
    s_cbranch_vccnz L_ev19
    s_waitcnt vmcnt(4)
L_ev19:
    buffer_load_dwordx4 v[228:231], v3, s[8:11], s16 offen offset:1024 nt
    s_add_u32 s38, s38, 1
    s_sub_u32 s51, s38, s49
    s_cmp_le_u32 s51, 2
    s_cbranch_scc0 L_xr2
    s_cmp_eq_u32 s51, 1
    s_cbranch_scc0 L_xa2
    v_lshrrev_b32 v76, 16, v54
    s_branch L_xr2
L_xa2:
    v_swap_b32 v8, v112
    v_swap_b32 v9, v113
    v_swap_b32 v10, v114
    v_swap_b32 v11, v115
    s_cmp_eq_u32 s51, 0
    s_cbranch_scc1 L_xr2
    v_or_b32 v76, v76, v54
    v_mov_b32 v127, 1
    ds_write_b32 v125, v76 offset:10752
    ds_write_b32 v124, v127 offset:4320
L_xr2:
    v_dot2_f32_bf16 v16, v192, v8, 0
    v_dot2_f32_bf16 v16, v193, v9, v16
    v_dot2_f32_bf16 v16, v194, v10, v16
    v_dot2_f32_bf16 v16, v195, v11, v16
    v_dot2_f32_bf16 v17, v196, v8, 0
    v_dot2_f32_bf16 v17, v197, v9, v17
    v_dot2_f32_bf16 v17, v198, v10, v17
    v_dot2_f32_bf16 v17, v199, v11, v17
    s_cmp_lt_i32 s31, 0
    s_cbranch_scc0 L_ew19
    s_waitcnt vmcnt(3)
L_ew19:
    s_waitcnt vmcnt(6)
    s_cbranch_vccnz L_ev20
    s_waitcnt vmcnt(4)
L_ev20:
    buffer_load_dwordx4 v[232:235], v3, s[8:11], s16 offen offset:2048 nt
    s_memrealtime s[34:35]
    v_dot2_f32_bf16 v18, v200, v8, 0
    v_dot2_f32_bf16 v18, v201, v9, v18
    v_dot2_f32_bf16 v18, v202, v10, v18
    v_dot2_f32_bf16 v18, v203, v11, v18
    v_dot2_f32_bf16 v19, v204, v8, 0
    v_dot2_f32_bf16 v19, v205, v9, v19
    v_dot2_f32_bf16 v19, v206, v10, v19
    v_dot2_f32_bf16 v19, v207, v11, v19
    s_waitcnt lgkmcnt(0)
    s_add_u32 s32, s34, s31
    s_sub_u32 s32, s32, s19
    s_cmp_gt_i32 s32, 0
    s_cselect_b64 vcc, -1, 0
    s_cselect_b32 s31, 27, 0
    s_add_u32 s19, s19, s30
    s_add_u32 s32, s32, s40
    s_cmp_lt_u32 s32, 2000
    s_cselect_b32 s31, -13, s31
    s_cmp_lt_i32 s31, 0
    s_cbranch_scc0 L_ew20
    s_waitcnt vmcnt(3)
L_ew20:
    s_waitcnt vmcnt(6)
    s_cbranch_vccnz L_ev21
    s_waitcnt vmcnt(4)
L_ev21:
    buffer_load_dwordx4 v[236:239], v3, s[8:11], s16 offen offset:3072 nt
    v_dot2_f32_bf16 v20, v208, v8, 0
    v_dot2_f32_bf16 v20, v209, v9, v20
    v_dot2_f32_bf16 v20, v210, v10, v20
    v_dot2_f32_bf16 v20, v211, v11, v20
    s_cmp_eq_u32 s18, s39
    s_cbranch_scc0 L_xsa
    ds_read_b32 v66, v56 offset:240
    ds_read_b32 v67, v56 offset:248
    ds_read2_b32 v[112:113], v75 offset0:0 offset1:2
    ds_read2_b32 v[114:115], v75 offset0:4 offset1:6
L_xsa:
    s_cmp_lt_i32 s31, 0
    s_cbranch_scc0 L_ew21
    s_waitcnt vmcnt(3)
L_ew21:
    s_waitcnt vmcnt(6)
    s_cbranch_vccnz L_ev22
    s_waitcnt vmcnt(4)
L_ev22:
    buffer_load_dwordx4 v[240:243], v4, s[8:11], s16 offen nt
    v_dot2_f32_bf16 v21, v212, v8, 0
    v_dot2_f32_bf16 v21, v213, v9, v21
    v_dot2_f32_bf16 v21, v214, v10, v21
    v_dot2_f32_bf16 v21, v215, v11, v21
    s_cmp_lt_i32 s31, 0
    s_cbranch_scc0 L_ew22
    s_waitcnt vmcnt(3)
L_ew22:
    s_waitcnt vmcnt(6)
    s_cbranch_vccnz L_ev23
    s_waitcnt vmcnt(4)
L_ev23:
    buffer_load_dwordx4 v[244:247], v4, s[8:11], s16 offen offset:1024 nt
    v_dot2_f32_bf16 v22, v216, v8, 0
    v_dot2_f32_bf16 v22, v217, v9, v22
    v_dot2_f32_bf16 v22, v218, v10, v22
    v_dot2_f32_bf16 v22, v219, v11, v22
    s_cmp_lt_i32 s31, 0
    s_cbranch_scc0 L_ew23
    s_waitcnt vmcnt(3)
L_ew23:
    s_waitcnt vmcnt(6)
    s_cbranch_vccnz L_ev24
    s_waitcnt vmcnt(4)
L_ev24:
    buffer_load_dwordx4 v[248:251], v4, s[8:11], s16 offen offset:2048 nt
    s_memrealtime s[34:35]
    v_dot2_f32_bf16 v23, v220, v8, 0
    v_dot2_f32_bf16 v23, v221, v9, v23
    v_dot2_f32_bf16 v23, v222, v10, v23
    v_dot2_f32_bf16 v23, v223, v11, v23
    s_cmp_eq_u32 s18, s39
    s_cbranch_scc0 L_xsb
L_xsc:
    s_waitcnt lgkmcnt(0)
    v_readfirstlane_b32 s51, v66
    v_readfirstlane_b32 s33, v67
    s_cmp_lg_u32 s51, 0
    s_cbranch_scc1 L_xsd
    ds_read_b32 v66, v56 offset:240
    ds_read_b32 v67, v56 offset:248
    ds_read2_b32 v[112:113], v75 offset0:0 offset1:2
    ds_read2_b32 v[114:115], v75 offset0:4 offset1:6
    s_branch L_xsc
L_xsd:
    s_xor_b32 s33, s33, s3
    s_and_b32 s33, s33, 1
    s_cselect_b32 s49, 99, s37
    v_mov_b32 v127, s33
    ds_write_b32 v124, v127 offset:4320
L_xsb:
    s_waitcnt lgkmcnt(0)
    s_add_u32 s32, s34, s31
    s_sub_u32 s32, s32, s19
    s_cmp_gt_i32 s32, 0
    s_cselect_b64 vcc, -1, 0
    s_cselect_b32 s31, 27, 0
    s_add_u32 s19, s19, s30
    s_add_u32 s32, s32, s40
    s_cmp_lt_u32 s32, 2000
    s_cselect_b32 s31, -13, s31
    s_cmp_lt_i32 s31, 0
    s_cbranch_scc0 L_ew24
    s_waitcnt vmcnt(3)
L_ew24:
    s_waitcnt vmcnt(6)
    s_cbranch_vccnz L_ev25
    s_waitcnt vmcnt(4)
L_ev25:
    buffer_load_dwordx4 v[252:255], v4, s[8:11], s16 offen offset:3072 nt
    s_add_u32 s14, s14, 0x20000
    s_and_b32 s16, s14, 0xe0000
    s_lshr_b32 s27, s14, 6
    s_and_b32 s27, s27, 0x4000
    s_or_b32 s16, s16, s27
    s_xor_b32 s16, s16, s15
    s_add_u32 s48, s48, 1
    s_sub_u32 s27, s48, s49
    s_cmp_lt_u32 s27, 2
    s_cselect_b32 s27, 0x422000, 0
    s_xor_b32 s16, s16, s27
    s_cmp_eq_u32 s18, 7
    s_cselect_b32 s8, s12, s8
    s_cselect_b32 s9, s13, s9
    v_dot2_f32_bf16 v24, v224, v8, 0
    v_dot2_f32_bf16 v24, v225, v9, v24
    v_dot2_f32_bf16 v24, v226, v10, v24
    v_dot2_f32_bf16 v24, v227, v11, v24
    s_cmp_lt_i32 s31, 0
    s_cbranch_scc0 L_ew25
    s_waitcnt vmcnt(3)
L_ew25:
    s_waitcnt vmcnt(6)
    s_cbranch_vccnz L_ev26
    s_waitcnt vmcnt(4)
L_ev26:
    buffer_load_dwordx4 v[128:131], v1, s[8:11], s16 offen nt
    v_dot2_f32_bf16 v25, v228, v8, 0
    v_dot2_f32_bf16 v25, v229, v9, v25
    v_dot2_f32_bf16 v25, v230, v10, v25
    v_dot2_f32_bf16 v25, v231, v11, v25
    v_add_f32_dpp v16, v16, v16 row_ror:8 row_mask:0xf bank_mask:0x3
    v_add_f32_dpp v16, v24, v24 row_ror:8 row_mask:0xf bank_mask:0xc
    s_cmp_lt_i32 s31, 0
    s_cbranch_scc0 L_ew26
    s_waitcnt vmcnt(3)
L_ew26:
    s_waitcnt vmcnt(6)
    s_cbranch_vccnz L_ev27
    s_waitcnt vmcnt(4)
L_ev27:
    buffer_load_dwordx4 v[132:135], v1, s[8:11], s16 offen offset:1024 nt
    v_dot2_f32_bf16 v26, v232, v8, 0
    v_dot2_f32_bf16 v26, v233, v9, v26
    v_dot2_f32_bf16 v26, v234, v10, v26
    v_dot2_f32_bf16 v26, v235, v11, v26
    v_add_f32_dpp v17, v17, v17 row_ror:8 row_mask:0xf bank_mask:0x3
    v_add_f32_dpp v17, v25, v25 row_ror:8 row_mask:0xf bank_mask:0xc
    s_cmp_lt_i32 s31, 0
    s_cbranch_scc0 L_ew27
    s_waitcnt vmcnt(3)
L_ew27:
    s_waitcnt vmcnt(6)
    s_cbranch_vccnz L_ev28
    s_waitcnt vmcnt(4)
L_ev28:
    buffer_load_dwordx4 v[136:139], v1, s[8:11], s16 offen offset:2048 nt
    s_memrealtime s[34:35]
    v_dot2_f32_bf16 v27, v236, v8, 0
    v_dot2_f32_bf16 v27, v237, v9, v27
    v_dot2_f32_bf16 v27, v238, v10, v27
    v_dot2_f32_bf16 v27, v239, v11, v27
    v_add_f32_dpp v18, v18, v18 row_ror:8 row_mask:0xf bank_mask:0x3
    v_add_f32_dpp v18, v26, v26 row_ror:8 row_mask:0xf bank_mask:0xc
    s_waitcnt lgkmcnt(0)
    s_add_u32 s32, s34, s31
    s_sub_u32 s32, s32, s19
    s_cmp_gt_i32 s32, 0
    s_cselect_b64 vcc, -1, 0
    s_cselect_b32 s31, 27, 0
    s_add_u32 s19, s19, s30
    s_add_u32 s32, s32, s40
    s_cmp_lt_u32 s32, 2000
    s_cselect_b32 s31, -13, s31
    s_cmp_lt_i32 s31, 0
    s_cbranch_scc0 L_ew28
    s_waitcnt vmcnt(3)
L_ew28:
    s_waitcnt vmcnt(6)
    s_cbranch_vccnz L_ev29
    s_waitcnt vmcnt(4)
L_ev29:
    buffer_load_dwordx4 v[140:143], v1, s[8:11], s16 offen offset:3072 nt
    v_dot2_f32_bf16 v28, v240, v8, 0
    v_dot2_f32_bf16 v28, v241, v9, v28
    v_dot2_f32_bf16 v28, v242, v10, v28
    v_dot2_f32_bf16 v28, v243, v11, v28
    v_add_f32_dpp v19, v19, v19 row_ror:8 row_mask:0xf bank_mask:0x3
    v_add_f32_dpp v19, v27, v27 row_ror:8 row_mask:0xf bank_mask:0xc
    s_cmp_lt_i32 s31, 0
    s_cbranch_scc0 L_ew29
    s_waitcnt vmcnt(3)
L_ew29:
    s_waitcnt vmcnt(6)
    s_cbranch_vccnz L_ev30
    s_waitcnt vmcnt(4)
L_ev30:
    buffer_load_dwordx4 v[144:147], v2, s[8:11], s16 offen nt
    v_dot2_f32_bf16 v29, v244, v8, 0
    v_dot2_f32_bf16 v29, v245, v9, v29
    v_dot2_f32_bf16 v29, v246, v10, v29
    v_dot2_f32_bf16 v29, v247, v11, v29
    v_add_f32_dpp v20, v20, v20 row_ror:8 row_mask:0xf bank_mask:0x3
    v_add_f32_dpp v20, v28, v28 row_ror:8 row_mask:0xf bank_mask:0xc
    s_cmp_lt_i32 s31, 0
    s_cbranch_scc0 L_ew30
    s_waitcnt vmcnt(3)
L_ew30:
    s_waitcnt vmcnt(6)
    s_cbranch_vccnz L_ev31
    s_waitcnt vmcnt(4)
L_ev31:
    buffer_load_dwordx4 v[148:151], v2, s[8:11], s16 offen offset:1024 nt
    v_dot2_f32_bf16 v30, v248, v8, 0
    v_dot2_f32_bf16 v30, v249, v9, v30
    v_dot2_f32_bf16 v30, v250, v10, v30
    v_dot2_f32_bf16 v30, v251, v11, v30
    v_add_f32_dpp v21, v21, v21 row_ror:8 row_mask:0xf bank_mask:0x3
    v_add_f32_dpp v21, v29, v29 row_ror:8 row_mask:0xf bank_mask:0xc
    s_cmp_lt_i32 s31, 0
    s_cbranch_scc0 L_ew31
    s_waitcnt vmcnt(3)
L_ew31:
    s_waitcnt vmcnt(6)
    s_cbranch_vccnz L_ev32
    s_waitcnt vmcnt(4)
L_ev32:
    buffer_load_dwordx4 v[152:155], v2, s[8:11], s16 offen offset:2048 nt
    s_memrealtime s[34:35]
    v_dot2_f32_bf16 v31, v252, v8, 0
    v_dot2_f32_bf16 v31, v253, v9, v31
    v_dot2_f32_bf16 v31, v254, v10, v31
    v_dot2_f32_bf16 v31, v255, v11, v31
    v_add_f32_dpp v22, v22, v22 row_ror:8 row_mask:0xf bank_mask:0x3
    v_add_f32_dpp v22, v30, v30 row_ror:8 row_mask:0xf bank_mask:0xc
    s_add_u32 s18, s18, 1
    s_cmp_lt_u32 s18, 8
    s_cbranch_scc1 L_kloop
    s_waitcnt lgkmcnt(0)
    s_add_u32 s32, s34, s31
    v_mov_b32 v63, s18
    v_mov_b32 v62, s32
    ds_write_b64 v57, v[62:63] offset:4272
    s_add_u32 s32, s34, s31
    s_sub_u32 s32, s32, s19
    s_cmp_gt_i32 s32, 0
    s_cselect_b64 vcc, -1, 0
    s_cselect_b32 s31, 27, 0
    s_add_u32 s19, s19, s30
    s_add_u32 s32, s32, s40
    s_cmp_lt_u32 s32, 2000
    s_cselect_b32 s31, -13, s31
    s_cmp_lt_i32 s31, 0
    s_cbranch_scc0 L_ew32
    s_waitcnt vmcnt(3)
L_ew32:
    s_waitcnt vmcnt(6)
    s_cbranch_vccnz L_ev33
    s_waitcnt vmcnt(4)
L_ev33:
    buffer_load_dwordx4 v[156:159], v2, s[8:11], s16 offen offset:3072 nt
L_sf:
    ds_read_b32 v64, v73 offset:4256
    ds_read_b64 v[40:41], v74 offset:5120
    s_waitcnt lgkmcnt(0)
    v_readfirstlane_b32 s33, v64
    s_nop 0
    s_cmp_eq_u32 s33, 0
    s_cbranch_scc1 L_sf
    v_add_f32_dpp v16, v16, v16 row_half_mirror row_mask:0xf bank_mask:0x5
    v_add_f32_dpp v16, v20, v20 row_half_mirror row_mask:0xf bank_mask:0xa
    v_add_f32_dpp v17, v17, v17 row_half_mirror row_mask:0xf bank_mask:0x5
    v_add_f32_dpp v17, v21, v21 row_half_mirror row_mask:0xf bank_mask:0xa
    v_add_f32_dpp v23, v23, v23 row_ror:8 row_mask:0xf bank_mask:0x3
    v_add_f32_dpp v23, v31, v31 row_ror:8 row_mask:0xf bank_mask:0xc
    v_add_f32_dpp v18, v18, v18 row_half_mirror row_mask:0xf bank_mask:0x5
    v_add_f32_dpp v18, v22, v22 row_half_mirror row_mask:0xf bank_mask:0xa
    v_add_f32_dpp v19, v19, v19 row_half_mirror row_mask:0xf bank_mask:0x5
    v_add_f32_dpp v19, v23, v23 row_half_mirror row_mask:0xf bank_mask:0xa
    v_add_f32_dpp v16, v16, v16 quad_perm:[2,3,0,1] row_mask:0xf bank_mask:0xf
    v_add_f32_dpp v17, v17, v17 quad_perm:[2,3,0,1] row_mask:0xf bank_mask:0xf
    v_add_f32_dpp v18, v18, v18 quad_perm:[2,3,0,1] row_mask:0xf bank_mask:0xf
    s_cmp_lt_i32 s31, 0
    s_cbranch_scc0 L_ew33
    s_waitcnt vmcnt(3)
L_ew33:
    s_waitcnt vmcnt(6)
    s_cbranch_vccnz L_ev34
    s_waitcnt vmcnt(4)
L_ev34:
    buffer_load_dwordx4 v[160:163], v3, s[8:11], s16 offen nt
    v_add_f32_dpp v19, v19, v19 quad_perm:[2,3,0,1] row_mask:0xf bank_mask:0xf
    v_cndmask_b32 v16, v16, v18, s[20:21]
    v_cndmask_b32 v17, v17, v19, s[20:21]
    s_nop 0
    v_add_f32_dpp v16, v16, v16 quad_perm:[1,0,3,2] row_mask:0xf bank_mask:0xf
    v_add_f32_dpp v17, v17, v17 quad_perm:[1,0,3,2] row_mask:0xf bank_mask:0xf
    v_cndmask_b32 v16, v16, v17, s[22:23]
    v_cvt_pk_bf16_f32 v55, v16, v16
    v_and_b32 v55, s26, v55
    v_mul_f32 v55, s24, v55
    v_cvt_pk_bf16_f32 v55, v55, v55
    v_and_b32 v55, s26, v55
    s_cmp_lt_u32 s42, 99
    s_cbranch_scc0 L_xcl_r
L_xcl:
    ds_read_b32 v127, v56 offset:244
    s_waitcnt lgkmcnt(0)
    v_readfirstlane_b32 s33, v127
    s_nop 0
    s_cmp_eq_u32 s33, 0
    s_cbranch_scc1 L_xcl
    s_xor_b32 s33, s33, s3
    s_bitcmp1_b32 s33, 0
    s_cselect_b32 s43, 0, 0x422000
    s_cselect_b32 s33, 1024, 0
    v_add_u32 v126, s33, v126
L_xcl_r:
    s_cmp_lt_i32 s31, 0
    s_cbranch_scc0 L_ew34
    s_waitcnt vmcnt(3)
L_ew34:
    s_waitcnt vmcnt(6)
    s_cbranch_vccnz L_ev35
    s_waitcnt vmcnt(4)
L_ev35:
    buffer_load_dwordx4 v[164:167], v3, s[8:11], s16 offen offset:1024 nt
    s_cmp_lt_u32 s49, 99
    s_cbranch_scc0 L_ximp_r
L_ximp:
    ds_read_b32 v66, v56 offset:240
    ds_read_b32 v127, v125 offset:8704
    s_waitcnt lgkmcnt(0)
    v_readfirstlane_b32 s33, v66
    s_nop 0
    s_cmp_lt_u32 s33, 2
    s_cbranch_scc1 L_ximp
    v_lshlrev_b32 v66, 16, v127
    v_and_b32 v127, s26, v127
    s_set_gpr_idx_on s49, gpr_idx(DST)
    s_nop 0
    v_mov_b32 v40, v66
    v_mov_b32 v41, v127
    s_set_gpr_idx_off
    s_nop 0
L_ximp_r:
    s_cmp_lt_i32 s31, 0
    s_cbranch_scc0 L_ew35
    s_waitcnt vmcnt(3)
L_ew35:
    s_waitcnt vmcnt(6)
    s_cbranch_vccnz L_ev36
    s_waitcnt vmcnt(4)
L_ev36:
    buffer_load_dwordx4 v[168:171], v3, s[8:11], s16 offen offset:2048 nt
    s_memrealtime s[34:35]
    v_max3_f32 v64, v40, v41, v42
    v_max3_f32 v64, v64, v43, v44
    v_max3_f32 v64, v64, v45, v46
    v_max3_f32 v64, v64, v47, v48
    v_max3_f32 v64, v64, v49, v50
    v_max3_f32 v64, v64, v51, v52
    v_max3_f32 v64, v64, v53, v54
    v_max_f32 v64, v64, v55
    s_nop 1
    v_max_f32_dpp v68, v64, v64 row_ror:8 row_mask:0xf bank_mask:0xf
    s_nop 1
    v_max_f32_dpp v68, v68, v68 row_ror:4 row_mask:0xf bank_mask:0xf
    s_waitcnt lgkmcnt(0)
    s_add_u32 s32, s34, s31
    s_sub_u32 s32, s32, s19
    s_cmp_gt_i32 s32, 0
    s_cselect_b64 vcc, -1, 0
    s_cselect_b32 s31, 27, 0
    s_add_u32 s19, s19, s30
    s_add_u32 s32, s32, s40
    s_cmp_lt_u32 s32, 2000
    s_cselect_b32 s31, -13, s31
    s_cmp_lt_i32 s31, 0
    s_cbranch_scc0 L_ew36
    s_waitcnt vmcnt(3)
L_ew36:
    s_waitcnt vmcnt(6)
    s_cbranch_vccnz L_ev37
    s_waitcnt vmcnt(4)
L_ev37:
    buffer_load_dwordx4 v[172:175], v3, s[8:11], s16 offen offset:3072 nt
    v_max_f32_dpp v68, v68, v68 row_ror:2 row_mask:0xf bank_mask:0xf
    s_nop 1
    v_max_f32_dpp v68, v68, v68 row_ror:1 row_mask:0xf bank_mask:0xf
    v_mov_b32 v65, v68
    s_nop 1
    v_permlane16_swap_b32 v68, v65
    v_max_f32 v68, v68, v65
    v_mov_b32 v65, v68
    s_nop 1
    v_permlane32_swap_b32 v68, v65
    v_max_f32 v68, v68, v65
    s_cmp_lt_i32 s31, 0
    s_cbranch_scc0 L_ew37
    s_waitcnt vmcnt(3)
L_ew37:
    s_waitcnt vmcnt(6)
    s_cbranch_vccnz L_ev38
    s_waitcnt vmcnt(4)
L_ev38:
    buffer_load_dwordx4 v[176:179], v4, s[8:11], s16 offen nt
    v_sub_f32 v40, v40, v68
    v_sub_f32 v41, v41, v68
    v_sub_f32 v42, v42, v68
    v_sub_f32 v43, v43, v68
    v_sub_f32 v44, v44, v68
    v_sub_f32 v45, v45, v68
    v_sub_f32 v46, v46, v68
    v_sub_f32 v47, v47, v68
    v_mul_f32 v40, s25, v40
    v_mul_f32 v41, s25, v41
    v_mul_f32 v42, s25, v42
    v_mul_f32 v43, s25, v43
    v_mul_f32 v44, s25, v44
    v_mul_f32 v45, s25, v45
    v_mul_f32 v46, s25, v46
    v_mul_f32 v47, s25, v47
    s_cmp_lt_i32 s31, 0
    s_cbranch_scc0 L_ew38
    s_waitcnt vmcnt(3)
L_ew38:
    s_waitcnt vmcnt(6)
    s_cbranch_vccnz L_ev39
    s_waitcnt vmcnt(4)
L_ev39:
    buffer_load_dwordx4 v[180:183], v4, s[8:11], s16 offen offset:1024 nt
    v_exp_f32 v40, v40
    v_exp_f32 v41, v41
    v_exp_f32 v42, v42
    v_exp_f32 v43, v43
    v_exp_f32 v44, v44
    v_exp_f32 v45, v45
    v_exp_f32 v46, v46
    v_exp_f32 v47, v47
    s_cmp_lt_i32 s31, 0
    s_cbranch_scc0 L_ew39
    s_waitcnt vmcnt(3)
L_ew39:
    s_waitcnt vmcnt(6)
    s_cbranch_vccnz L_ev40
    s_waitcnt vmcnt(4)
L_ev40:
    buffer_load_dwordx4 v[184:187], v4, s[8:11], s16 offen offset:2048 nt
    s_memrealtime s[34:35]
    v_sub_f32 v48, v48, v68
    v_sub_f32 v49, v49, v68
    v_sub_f32 v50, v50, v68
    v_sub_f32 v51, v51, v68
    v_sub_f32 v52, v52, v68
    v_sub_f32 v53, v53, v68
    v_sub_f32 v54, v54, v68
    v_sub_f32 v55, v55, v68
    v_mul_f32 v48, s25, v48
    v_mul_f32 v49, s25, v49
    v_mul_f32 v50, s25, v50
    v_mul_f32 v51, s25, v51
    v_mul_f32 v52, s25, v52
    v_mul_f32 v53, s25, v53
    v_mul_f32 v54, s25, v54
    v_mul_f32 v55, s25, v55
    s_waitcnt lgkmcnt(0)
    s_add_u32 s32, s34, s31
    s_sub_u32 s32, s32, s19
    s_cmp_gt_i32 s32, 0
    s_cselect_b64 vcc, -1, 0
    s_cselect_b32 s31, 27, 0
    s_add_u32 s19, s19, s30
    s_add_u32 s32, s32, s40
    s_cmp_lt_u32 s32, 2000
    s_cselect_b32 s31, -13, s31
    s_cmp_lt_i32 s31, 0
    s_cbranch_scc0 L_ew40
    s_waitcnt vmcnt(3)
L_ew40:
    s_waitcnt vmcnt(6)
    s_cbranch_vccnz L_ev41
    s_waitcnt vmcnt(4)
L_ev41:
    buffer_load_dwordx4 v[188:191], v4, s[8:11], s16 offen offset:3072 nt
    s_add_u32 s14, s14, 0x20000
    s_and_b32 s16, s14, 0xe0000
    s_lshr_b32 s27, s14, 6
    s_and_b32 s27, s27, 0x4000
    s_or_b32 s16, s16, s27
    s_xor_b32 s16, s16, s15
    v_exp_f32 v48, v48
    v_exp_f32 v49, v49
    v_exp_f32 v50, v50
    v_exp_f32 v51, v51
    v_exp_f32 v52, v52
    v_exp_f32 v53, v53
    v_exp_f32 v54, v54
    v_exp_f32 v55, v55
    s_cmp_lt_i32 s31, 0
    s_cbranch_scc0 L_ew41
    s_waitcnt vmcnt(3)
L_ew41:
    s_waitcnt vmcnt(6)
    s_cbranch_vccnz L_ev42
    s_waitcnt vmcnt(4)
L_ev42:
    buffer_load_dwordx4 v[192:195], v1, s[8:11], s16 offen nt
    v_add_f32 v64, v40, v41
    v_add_f32 v65, v42, v43
    v_add_f32 v64, v64, v44
    v_add_f32 v65, v65, v45
    v_add_f32 v64, v64, v46
    v_add_f32 v65, v65, v47
    v_add_f32 v64, v64, v48
    v_add_f32 v65, v65, v49
    v_add_f32 v64, v64, v50
    v_add_f32 v65, v65, v51
    v_add_f32 v64, v64, v52
    v_add_f32 v65, v65, v53
    v_add_f32 v64, v64, v54
    v_add_f32 v65, v65, v55
    v_add_f32 v64, v64, v65
    s_cmp_lt_i32 s31, 0
    s_cbranch_scc0 L_ew42
    s_waitcnt vmcnt(3)
L_ew42:
    s_waitcnt vmcnt(6)
    s_cbranch_vccnz L_ev43
    s_waitcnt vmcnt(4)
L_ev43:
    buffer_load_dwordx4 v[196:199], v1, s[8:11], s16 offen offset:1024 nt
    v_add_f32_dpp v69, v64, v64 row_ror:8 row_mask:0xf bank_mask:0xf
    s_nop 1
    v_add_f32_dpp v69, v69, v69 row_ror:4 row_mask:0xf bank_mask:0xf
    s_nop 1
    v_add_f32_dpp v69, v69, v69 row_ror:2 row_mask:0xf bank_mask:0xf
    s_nop 1
    v_add_f32_dpp v69, v69, v69 row_ror:1 row_mask:0xf bank_mask:0xf
    v_mov_b32 v65, v69
    s_nop 1
    v_permlane16_swap_b32 v69, v65
    v_add_f32 v69, v69, v65
    v_mov_b32 v65, v69
    s_nop 1
    v_permlane32_swap_b32 v69, v65
    v_add_f32 v69, v69, v65
    v_mov_b32 v70, 1
    ds_write_b96 v72, v[68:70]
    ds_read_b96 v[58:60], v56 offset:128
    ds_read_b32 v0, v56 offset:140
    s_cmp_lt_i32 s31, 0
    s_cbranch_scc0 L_ew43
    s_waitcnt vmcnt(3)
L_ew43:
    s_waitcnt vmcnt(6)
    s_cbranch_vccnz L_ev44
    s_waitcnt vmcnt(4)
L_ev44:
    buffer_load_dwordx4 v[200:203], v1, s[8:11], s16 offen offset:2048 nt
    s_memrealtime s[34:35]
    s_waitcnt lgkmcnt(0)
    v_readfirstlane_b32 s32, v60
    v_readfirstlane_b32 s33, v58
    v_readfirstlane_b32 s36, v59
    v_readfirstlane_b32 s40, v0
    s_cmp_eq_u32 s32, s18
    s_cselect_b32 s19, s33, s19
    s_cselect_b32 s30, s36, s30
    s_add_u32 s32, s34, s31
    s_sub_u32 s32, s32, s19
    s_cmp_gt_i32 s32, 0
    s_cselect_b64 vcc, -1, 0
    s_cselect_b32 s31, 27, 0
    s_add_u32 s19, s19, s30
    s_add_u32 s32, s32, s40
    s_cmp_lt_u32 s32, 2000
    s_cselect_b32 s31, -13, s31
    s_cmp_lt_i32 s31, 0
    s_cbranch_scc0 L_ew44
    s_waitcnt vmcnt(3)
L_ew44:
    s_waitcnt vmcnt(6)
    s_cbranch_vccnz L_ev45
    s_waitcnt vmcnt(4)
L_ev45:
    buffer_load_dwordx4 v[204:207], v1, s[8:11], s16 offen offset:3072 nt
    s_cmp_lt_i32 s31, 0
    s_cbranch_scc0 L_ew45
    s_waitcnt vmcnt(3)
L_ew45:
    s_waitcnt vmcnt(6)
    s_cbranch_vccnz L_ev46
    s_waitcnt vmcnt(4)
L_ev46:
    buffer_load_dwordx4 v[208:211], v2, s[8:11], s16 offen nt
L_sync:
    ds_read_b96 v[80:82], v56 offset:0
    ds_read_b96 v[84:86], v56 offset:16
    ds_read_b96 v[88:90], v56 offset:32
    ds_read_b96 v[92:94], v56 offset:48
    s_waitcnt lgkmcnt(0)
    v_min_u32 v64, v82, v86
    v_min3_u32 v64, v64, v90, v94
    s_nop 0
    v_readfirstlane_b32 s33, v64
    s_nop 0
    s_cmp_eq_u32 s33, 0
    s_cbranch_scc1 L_sync
    ds_read_b64 v[80:81], v56 offset:0
    ds_read_b64 v[84:85], v56 offset:16
    ds_read_b64 v[88:89], v56 offset:32
    ds_read_b64 v[92:93], v56 offset:48
    s_cmp_lt_i32 s31, 0
    s_cbranch_scc0 L_ew46
    s_waitcnt vmcnt(3)
L_ew46:
    s_waitcnt vmcnt(6)
    s_cbranch_vccnz L_ev47
    s_waitcnt vmcnt(4)
L_ev47:
    buffer_load_dwordx4 v[212:215], v2, s[8:11], s16 offen offset:1024 nt
    s_waitcnt lgkmcnt(0)
    v_max_f32 v64, v80, v84
    v_max3_f32 v64, v64, v88, v92
    v_sub_f32 v80, v80, v64
    v_sub_f32 v84, v84, v64
    v_sub_f32 v88, v88, v64
    v_sub_f32 v92, v92, v64
    v_sub_f32 v65, v68, v64
    v_mul_f32 v80, s25, v80
    v_mul_f32 v84, s25, v84
    v_mul_f32 v88, s25, v88
    v_mul_f32 v92, s25, v92
    v_mul_f32 v65, s25, v65
    s_cmp_lt_i32 s31, 0
    s_cbranch_scc0 L_ew47
    s_waitcnt vmcnt(3)
L_ew47:
    s_waitcnt vmcnt(6)
    s_cbranch_vccnz L_ev48
    s_waitcnt vmcnt(4)
L_ev48:
    buffer_load_dwordx4 v[216:219], v2, s[8:11], s16 offen offset:2048 nt
    s_memrealtime s[34:35]
    v_exp_f32 v80, v80
    v_exp_f32 v84, v84
    v_exp_f32 v88, v88
    v_exp_f32 v92, v92
    v_exp_f32 v65, v65
    v_mul_f32 v64, v80, v81
    v_fmac_f32 v64, v84, v85
    v_fmac_f32 v64, v88, v89
    v_fmac_f32 v64, v92, v93
    v_rcp_f32 v64, v64
    s_nop 0
    v_mul_f32 v64, v64, v65
    s_waitcnt lgkmcnt(0)
    s_add_u32 s32, s34, s31
    s_sub_u32 s32, s32, s19
    s_cmp_gt_i32 s32, 0
    s_cselect_b64 vcc, -1, 0
    s_cselect_b32 s31, 27, 0
    s_add_u32 s19, s19, s30
    s_add_u32 s32, s32, s40
    s_cmp_lt_u32 s32, 2000
    s_cselect_b32 s31, -13, s31
    s_cmp_lt_i32 s31, 0
    s_cbranch_scc0 L_ew48
    s_waitcnt vmcnt(3)
L_ew48:
    s_waitcnt vmcnt(6)
    s_cbranch_vccnz L_ev49
    s_waitcnt vmcnt(4)
L_ev49:
    buffer_load_dwordx4 v[220:223], v2, s[8:11], s16 offen offset:3072 nt
    v_mul_f32 v40, v64, v40
    v_mul_f32 v41, v64, v41
    v_mul_f32 v42, v64, v42
    v_mul_f32 v43, v64, v43
    v_mul_f32 v44, v64, v44
    v_mul_f32 v45, v64, v45
    v_mul_f32 v46, v64, v46
    v_mul_f32 v47, v64, v47
    v_mul_f32 v48, v64, v48
    v_mul_f32 v49, v64, v49
    v_mul_f32 v50, v64, v50
    v_mul_f32 v51, v64, v51
    v_mul_f32 v52, v64, v52
    v_mul_f32 v53, v64, v53
    v_mul_f32 v54, v64, v54
    v_mul_f32 v55, v64, v55
    s_cmp_lt_i32 s31, 0
    s_cbranch_scc0 L_ew49
    s_waitcnt vmcnt(3)
L_ew49:
    s_waitcnt vmcnt(6)
    s_cbranch_vccnz L_ev50
    s_waitcnt vmcnt(4)
L_ev50:
    buffer_load_dwordx4 v[224:227], v3, s[8:11], s16 offen nt
    v_cvt_pk_bf16_f32 v12, v40, 0
    v_cvt_pk_bf16_f32 v40, v41, 0
    v_cvt_pk_bf16_f32 v41, v42, 0
    v_cvt_pk_bf16_f32 v42, v43, 0
    v_cvt_pk_bf16_f32 v43, v44, 0
    v_cvt_pk_bf16_f32 v44, v45, 0
    v_cvt_pk_bf16_f32 v45, v46, 0
    v_cvt_pk_bf16_f32 v46, v47, 0
    v_cvt_pk_bf16_f32 v47, v48, 0
    v_cvt_pk_bf16_f32 v48, v49, 0
    v_cvt_pk_bf16_f32 v49, v50, 0
    v_cvt_pk_bf16_f32 v50, v51, 0
    v_cvt_pk_bf16_f32 v51, v52, 0
    v_cvt_pk_bf16_f32 v52, v53, 0
    v_cvt_pk_bf16_f32 v53, v54, 0
    v_cvt_pk_bf16_f32 v54, v55, 0
    v_lshlrev_b32 v13, 16, v12
    s_cmp_eq_u32 s43, 0
    s_cbranch_scc1 L_xexp_r
    s_sub_u32 s33, s42, 17
    s_set_gpr_idx_on s33, gpr_idx(SRC0)
    s_nop 0
    v_mov_b32 v127, v40
    v_mov_b32 v112, v41
    s_set_gpr_idx_off
    s_nop 0
    v_lshl_or_b32 v127, v112, 16, v127
    ds_write_b32 v125, v127 offset:11264
L_xexp_r:
    v_mov_b32 v64, 2
    ds_write_b32 v124, v64 offset:4320
    s_cmp_lt_i32 s31, 0
    s_cbranch_scc0 L_ew50
    s_waitcnt vmcnt(3)
L_ew50:
    s_waitcnt vmcnt(6)
    s_cbranch_vccnz L_ev51
    s_waitcnt vmcnt(4)
L_ev51:
    buffer_load_dwordx4 v[228:231], v3, s[8:11], s16 offen offset:1024 nt
    v_dot2c_f32_bf16_dpp v32, v12, v128 row_newbcast:0 row_mask:0xf bank_mask:0xf
    v_dot2c_f32_bf16_dpp v33, v13, v128 row_newbcast:0 row_mask:0xf bank_mask:0xf
    v_dot2c_f32_bf16_dpp v34, v12, v129 row_newbcast:0 row_mask:0xf bank_mask:0xf
    v_dot2c_f32_bf16_dpp v35, v13, v129 row_newbcast:0 row_mask:0xf bank_mask:0xf
    v_dot2c_f32_bf16_dpp v36, v12, v130 row_newbcast:0 row_mask:0xf bank_mask:0xf
    v_dot2c_f32_bf16_dpp v37, v13, v130 row_newbcast:0 row_mask:0xf bank_mask:0xf
    v_dot2c_f32_bf16_dpp v38, v12, v131 row_newbcast:0 row_mask:0xf bank_mask:0xf
    v_dot2c_f32_bf16_dpp v39, v13, v131 row_newbcast:0 row_mask:0xf bank_mask:0xf
    v_mov_b32 v14, v40
    v_lshlrev_b32 v15, 16, v40
    v_dot2c_f32_bf16_dpp v32, v12, v132 row_newbcast:1 row_mask:0xf bank_mask:0xf
    v_dot2c_f32_bf16_dpp v33, v13, v132 row_newbcast:1 row_mask:0xf bank_mask:0xf
    v_dot2c_f32_bf16_dpp v34, v12, v133 row_newbcast:1 row_mask:0xf bank_mask:0xf
    v_dot2c_f32_bf16_dpp v35, v13, v133 row_newbcast:1 row_mask:0xf bank_mask:0xf
    v_dot2c_f32_bf16_dpp v36, v12, v134 row_newbcast:1 row_mask:0xf bank_mask:0xf
    v_dot2c_f32_bf16_dpp v37, v13, v134 row_newbcast:1 row_mask:0xf bank_mask:0xf
    v_dot2c_f32_bf16_dpp v38, v12, v135 row_newbcast:1 row_mask:0xf bank_mask:0xf
    v_dot2c_f32_bf16_dpp v39, v13, v135 row_newbcast:1 row_mask:0xf bank_mask:0xf
    v_mov_b32 v40, v41
    s_cmp_lt_i32 s31, 0
    s_cbranch_scc0 L_ew51
    s_waitcnt vmcnt(3)
L_ew51:
    s_waitcnt vmcnt(6)
    s_cbranch_vccnz L_ev52
    s_waitcnt vmcnt(4)
L_ev52:
    buffer_load_dwordx4 v[232:235], v3, s[8:11], s16 offen offset:2048 nt
    s_memrealtime s[34:35]
    v_dot2c_f32_bf16_dpp v32, v12, v136 row_newbcast:2 row_mask:0xf bank_mask:0xf
    v_dot2c_f32_bf16_dpp v33, v13, v136 row_newbcast:2 row_mask:0xf bank_mask:0xf
    v_dot2c_f32_bf16_dpp v34, v12, v137 row_newbcast:2 row_mask:0xf bank_mask:0xf
    v_dot2c_f32_bf16_dpp v35, v13, v137 row_newbcast:2 row_mask:0xf bank_mask:0xf
    v_dot2c_f32_bf16_dpp v36, v12, v138 row_newbcast:2 row_mask:0xf bank_mask:0xf
    v_dot2c_f32_bf16_dpp v37, v13, v138 row_newbcast:2 row_mask:0xf bank_mask:0xf
    v_dot2c_f32_bf16_dpp v38, v12, v139 row_newbcast:2 row_mask:0xf bank_mask:0xf
    v_dot2c_f32_bf16_dpp v39, v13, v139 row_newbcast:2 row_mask:0xf bank_mask:0xf
    v_mov_b32 v41, v42
    v_dot2c_f32_bf16_dpp v32, v12, v140 row_newbcast:3 row_mask:0xf bank_mask:0xf
    v_dot2c_f32_bf16_dpp v33, v13, v140 row_newbcast:3 row_mask:0xf bank_mask:0xf
    v_dot2c_f32_bf16_dpp v34, v12, v141 row_newbcast:3 row_mask:0xf bank_mask:0xf
    v_dot2c_f32_bf16_dpp v35, v13, v141 row_newbcast:3 row_mask:0xf bank_mask:0xf
    v_dot2c_f32_bf16_dpp v36, v12, v142 row_newbcast:3 row_mask:0xf bank_mask:0xf
    v_dot2c_f32_bf16_dpp v37, v13, v142 row_newbcast:3 row_mask:0xf bank_mask:0xf
    v_dot2c_f32_bf16_dpp v38, v12, v143 row_newbcast:3 row_mask:0xf bank_mask:0xf
    v_dot2c_f32_bf16_dpp v39, v13, v143 row_newbcast:3 row_mask:0xf bank_mask:0xf
    v_mov_b32 v42, v43
    s_waitcnt lgkmcnt(0)
    s_add_u32 s32, s34, s31
    s_sub_u32 s32, s32, s19
    s_cmp_gt_i32 s32, 0
    s_cselect_b64 vcc, -1, 0
    s_cselect_b32 s31, 27, 0
    s_add_u32 s19, s19, s30
    s_add_u32 s32, s32, s40
    s_cmp_lt_u32 s32, 2000
    s_cselect_b32 s31, -13, s31
    s_cmp_lt_i32 s31, 0
    s_cbranch_scc0 L_ew52
    s_waitcnt vmcnt(3)
L_ew52:
    s_waitcnt vmcnt(6)
    s_cbranch_vccnz L_ev53
    s_waitcnt vmcnt(4)
L_ev53:
    buffer_load_dwordx4 v[236:239], v3, s[8:11], s16 offen offset:3072 nt
    v_dot2c_f32_bf16_dpp v32, v12, v144 row_newbcast:4 row_mask:0xf bank_mask:0xf
    v_dot2c_f32_bf16_dpp v33, v13, v144 row_newbcast:4 row_mask:0xf bank_mask:0xf
    v_dot2c_f32_bf16_dpp v34, v12, v145 row_newbcast:4 row_mask:0xf bank_mask:0xf
    v_dot2c_f32_bf16_dpp v35, v13, v145 row_newbcast:4 row_mask:0xf bank_mask:0xf
    v_dot2c_f32_bf16_dpp v36, v12, v146 row_newbcast:4 row_mask:0xf bank_mask:0xf
    v_dot2c_f32_bf16_dpp v37, v13, v146 row_newbcast:4 row_mask:0xf bank_mask:0xf
    v_dot2c_f32_bf16_dpp v38, v12, v147 row_newbcast:4 row_mask:0xf bank_mask:0xf
    v_dot2c_f32_bf16_dpp v39, v13, v147 row_newbcast:4 row_mask:0xf bank_mask:0xf
    v_mov_b32 v43, v44
    v_dot2c_f32_bf16_dpp v32, v12, v148 row_newbcast:5 row_mask:0xf bank_mask:0xf
    v_dot2c_f32_bf16_dpp v33, v13, v148 row_newbcast:5 row_mask:0xf bank_mask:0xf
    v_dot2c_f32_bf16_dpp v34, v12, v149 row_newbcast:5 row_mask:0xf bank_mask:0xf
    v_dot2c_f32_bf16_dpp v35, v13, v149 row_newbcast:5 row_mask:0xf bank_mask:0xf
    v_dot2c_f32_bf16_dpp v36, v12, v150 row_newbcast:5 row_mask:0xf bank_mask:0xf
    v_dot2c_f32_bf16_dpp v37, v13, v150 row_newbcast:5 row_mask:0xf bank_mask:0xf
    v_dot2c_f32_bf16_dpp v38, v12, v151 row_newbcast:5 row_mask:0xf bank_mask:0xf
    v_dot2c_f32_bf16_dpp v39, v13, v151 row_newbcast:5 row_mask:0xf bank_mask:0xf
    v_mov_b32 v44, v45
    s_cmp_lt_i32 s31, 0
    s_cbranch_scc0 L_ew53
    s_waitcnt vmcnt(3)
L_ew53:
    s_waitcnt vmcnt(6)
    s_cbranch_vccnz L_ev54
    s_waitcnt vmcnt(4)
L_ev54:
    buffer_load_dwordx4 v[240:243], v4, s[8:11], s16 offen nt
    v_dot2c_f32_bf16_dpp v32, v12, v152 row_newbcast:6 row_mask:0xf bank_mask:0xf
    v_dot2c_f32_bf16_dpp v33, v13, v152 row_newbcast:6 row_mask:0xf bank_mask:0xf
    v_dot2c_f32_bf16_dpp v34, v12, v153 row_newbcast:6 row_mask:0xf bank_mask:0xf
    v_dot2c_f32_bf16_dpp v35, v13, v153 row_newbcast:6 row_mask:0xf bank_mask:0xf
    v_dot2c_f32_bf16_dpp v36, v12, v154 row_newbcast:6 row_mask:0xf bank_mask:0xf
    v_dot2c_f32_bf16_dpp v37, v13, v154 row_newbcast:6 row_mask:0xf bank_mask:0xf
    v_dot2c_f32_bf16_dpp v38, v12, v155 row_newbcast:6 row_mask:0xf bank_mask:0xf
    v_dot2c_f32_bf16_dpp v39, v13, v155 row_newbcast:6 row_mask:0xf bank_mask:0xf
    v_mov_b32 v45, v46
    v_dot2c_f32_bf16_dpp v32, v12, v156 row_newbcast:7 row_mask:0xf bank_mask:0xf
    v_dot2c_f32_bf16_dpp v33, v13, v156 row_newbcast:7 row_mask:0xf bank_mask:0xf
    v_dot2c_f32_bf16_dpp v34, v12, v157 row_newbcast:7 row_mask:0xf bank_mask:0xf
    v_dot2c_f32_bf16_dpp v35, v13, v157 row_newbcast:7 row_mask:0xf bank_mask:0xf
    v_dot2c_f32_bf16_dpp v36, v12, v158 row_newbcast:7 row_mask:0xf bank_mask:0xf
    v_dot2c_f32_bf16_dpp v37, v13, v158 row_newbcast:7 row_mask:0xf bank_mask:0xf
    v_dot2c_f32_bf16_dpp v38, v12, v159 row_newbcast:7 row_mask:0xf bank_mask:0xf
    v_dot2c_f32_bf16_dpp v39, v13, v159 row_newbcast:7 row_mask:0xf bank_mask:0xf
    v_mov_b32 v46, v47
    v_dot2c_f32_bf16_dpp v32, v12, v160 row_newbcast:8 row_mask:0xf bank_mask:0xf
    v_dot2c_f32_bf16_dpp v33, v13, v160 row_newbcast:8 row_mask:0xf bank_mask:0xf
    v_dot2c_f32_bf16_dpp v34, v12, v161 row_newbcast:8 row_mask:0xf bank_mask:0xf
    v_dot2c_f32_bf16_dpp v35, v13, v161 row_newbcast:8 row_mask:0xf bank_mask:0xf
    v_dot2c_f32_bf16_dpp v36, v12, v162 row_newbcast:8 row_mask:0xf bank_mask:0xf
    v_dot2c_f32_bf16_dpp v37, v13, v162 row_newbcast:8 row_mask:0xf bank_mask:0xf
    v_dot2c_f32_bf16_dpp v38, v12, v163 row_newbcast:8 row_mask:0xf bank_mask:0xf
    v_dot2c_f32_bf16_dpp v39, v13, v163 row_newbcast:8 row_mask:0xf bank_mask:0xf
    v_mov_b32 v47, v48
    s_cmp_lt_i32 s31, 0
    s_cbranch_scc0 L_ew54
    s_waitcnt vmcnt(3)
L_ew54:
    s_waitcnt vmcnt(6)
    s_cbranch_vccnz L_ev55
    s_waitcnt vmcnt(4)
L_ev55:
    buffer_load_dwordx4 v[244:247], v4, s[8:11], s16 offen offset:1024 nt
    v_dot2c_f32_bf16_dpp v32, v12, v164 row_newbcast:9 row_mask:0xf bank_mask:0xf
    v_dot2c_f32_bf16_dpp v33, v13, v164 row_newbcast:9 row_mask:0xf bank_mask:0xf
    v_dot2c_f32_bf16_dpp v34, v12, v165 row_newbcast:9 row_mask:0xf bank_mask:0xf
    v_dot2c_f32_bf16_dpp v35, v13, v165 row_newbcast:9 row_mask:0xf bank_mask:0xf
    v_dot2c_f32_bf16_dpp v36, v12, v166 row_newbcast:9 row_mask:0xf bank_mask:0xf
    v_dot2c_f32_bf16_dpp v37, v13, v166 row_newbcast:9 row_mask:0xf bank_mask:0xf
    v_dot2c_f32_bf16_dpp v38, v12, v167 row_newbcast:9 row_mask:0xf bank_mask:0xf
    v_dot2c_f32_bf16_dpp v39, v13, v167 row_newbcast:9 row_mask:0xf bank_mask:0xf
    v_mov_b32 v48, v49
    v_dot2c_f32_bf16_dpp v32, v12, v168 row_newbcast:10 row_mask:0xf bank_mask:0xf
    v_dot2c_f32_bf16_dpp v33, v13, v168 row_newbcast:10 row_mask:0xf bank_mask:0xf
    v_dot2c_f32_bf16_dpp v34, v12, v169 row_newbcast:10 row_mask:0xf bank_mask:0xf
    v_dot2c_f32_bf16_dpp v35, v13, v169 row_newbcast:10 row_mask:0xf bank_mask:0xf
    v_dot2c_f32_bf16_dpp v36, v12, v170 row_newbcast:10 row_mask:0xf bank_mask:0xf
    v_dot2c_f32_bf16_dpp v37, v13, v170 row_newbcast:10 row_mask:0xf bank_mask:0xf
    v_dot2c_f32_bf16_dpp v38, v12, v171 row_newbcast:10 row_mask:0xf bank_mask:0xf
    v_dot2c_f32_bf16_dpp v39, v13, v171 row_newbcast:10 row_mask:0xf bank_mask:0xf
    v_mov_b32 v49, v50
    s_cmp_lt_i32 s31, 0
    s_cbranch_scc0 L_ew55
    s_waitcnt vmcnt(3)
L_ew55:
    s_waitcnt vmcnt(6)
    s_cbranch_vccnz L_ev56
    s_waitcnt vmcnt(4)
L_ev56:
    buffer_load_dwordx4 v[248:251], v4, s[8:11], s16 offen offset:2048 nt
    s_memrealtime s[34:35]
    v_dot2c_f32_bf16_dpp v32, v12, v172 row_newbcast:11 row_mask:0xf bank_mask:0xf
    v_dot2c_f32_bf16_dpp v33, v13, v172 row_newbcast:11 row_mask:0xf bank_mask:0xf
    v_dot2c_f32_bf16_dpp v34, v12, v173 row_newbcast:11 row_mask:0xf bank_mask:0xf
    v_dot2c_f32_bf16_dpp v35, v13, v173 row_newbcast:11 row_mask:0xf bank_mask:0xf
    v_dot2c_f32_bf16_dpp v36, v12, v174 row_newbcast:11 row_mask:0xf bank_mask:0xf
    v_dot2c_f32_bf16_dpp v37, v13, v174 row_newbcast:11 row_mask:0xf bank_mask:0xf
    v_dot2c_f32_bf16_dpp v38, v12, v175 row_newbcast:11 row_mask:0xf bank_mask:0xf
    v_dot2c_f32_bf16_dpp v39, v13, v175 row_newbcast:11 row_mask:0xf bank_mask:0xf
    v_mov_b32 v50, v51
    v_dot2c_f32_bf16_dpp v32, v12, v176 row_newbcast:12 row_mask:0xf bank_mask:0xf
    v_dot2c_f32_bf16_dpp v33, v13, v176 row_newbcast:12 row_mask:0xf bank_mask:0xf
    v_dot2c_f32_bf16_dpp v34, v12, v177 row_newbcast:12 row_mask:0xf bank_mask:0xf
    v_dot2c_f32_bf16_dpp v35, v13, v177 row_newbcast:12 row_mask:0xf bank_mask:0xf
    v_dot2c_f32_bf16_dpp v36, v12, v178 row_newbcast:12 row_mask:0xf bank_mask:0xf
    v_dot2c_f32_bf16_dpp v37, v13, v178 row_newbcast:12 row_mask:0xf bank_mask:0xf
    v_dot2c_f32_bf16_dpp v38, v12, v179 row_newbcast:12 row_mask:0xf bank_mask:0xf
    v_dot2c_f32_bf16_dpp v39, v13, v179 row_newbcast:12 row_mask:0xf bank_mask:0xf
    v_mov_b32 v51, v52
    s_waitcnt lgkmcnt(0)
    s_add_u32 s32, s34, s31
    s_sub_u32 s32, s32, s19
    s_cmp_gt_i32 s32, 0
    s_cselect_b64 vcc, -1, 0
    s_cselect_b32 s31, 27, 0
    s_add_u32 s19, s19, s30
    s_add_u32 s32, s32, s40
    s_cmp_lt_u32 s32, 2000
    s_cselect_b32 s31, -13, s31
    s_cmp_lt_i32 s31, 0
    s_cbranch_scc0 L_ew56
    s_waitcnt vmcnt(3)
L_ew56:
    s_waitcnt vmcnt(6)
    s_cbranch_vccnz L_ev57
    s_waitcnt vmcnt(4)
L_ev57:
    buffer_load_dwordx4 v[252:255], v4, s[8:11], s16 offen offset:3072 nt
    s_add_u32 s14, s14, 0x20000
    s_and_b32 s16, s14, 0xe0000
    s_lshr_b32 s27, s14, 6
    s_and_b32 s27, s27, 0x4000
    s_or_b32 s16, s16, s27
    s_xor_b32 s16, s16, s15
    v_dot2c_f32_bf16_dpp v32, v12, v180 row_newbcast:13 row_mask:0xf bank_mask:0xf
    v_dot2c_f32_bf16_dpp v33, v13, v180 row_newbcast:13 row_mask:0xf bank_mask:0xf
    v_dot2c_f32_bf16_dpp v34, v12, v181 row_newbcast:13 row_mask:0xf bank_mask:0xf
    v_dot2c_f32_bf16_dpp v35, v13, v181 row_newbcast:13 row_mask:0xf bank_mask:0xf
    v_dot2c_f32_bf16_dpp v36, v12, v182 row_newbcast:13 row_mask:0xf bank_mask:0xf
    v_dot2c_f32_bf16_dpp v37, v13, v182 row_newbcast:13 row_mask:0xf bank_mask:0xf
    v_dot2c_f32_bf16_dpp v38, v12, v183 row_newbcast:13 row_mask:0xf bank_mask:0xf
    v_dot2c_f32_bf16_dpp v39, v13, v183 row_newbcast:13 row_mask:0xf bank_mask:0xf
    v_mov_b32 v52, v53
    v_dot2c_f32_bf16_dpp v32, v12, v184 row_newbcast:14 row_mask:0xf bank_mask:0xf
    v_dot2c_f32_bf16_dpp v33, v13, v184 row_newbcast:14 row_mask:0xf bank_mask:0xf
    v_dot2c_f32_bf16_dpp v34, v12, v185 row_newbcast:14 row_mask:0xf bank_mask:0xf
    v_dot2c_f32_bf16_dpp v35, v13, v185 row_newbcast:14 row_mask:0xf bank_mask:0xf
    v_dot2c_f32_bf16_dpp v36, v12, v186 row_newbcast:14 row_mask:0xf bank_mask:0xf
    v_dot2c_f32_bf16_dpp v37, v13, v186 row_newbcast:14 row_mask:0xf bank_mask:0xf
    v_dot2c_f32_bf16_dpp v38, v12, v187 row_newbcast:14 row_mask:0xf bank_mask:0xf
    v_dot2c_f32_bf16_dpp v39, v13, v187 row_newbcast:14 row_mask:0xf bank_mask:0xf
    v_mov_b32 v53, v54
    v_dot2c_f32_bf16_dpp v32, v12, v188 row_newbcast:15 row_mask:0xf bank_mask:0xf
    v_dot2c_f32_bf16_dpp v33, v13, v188 row_newbcast:15 row_mask:0xf bank_mask:0xf
    v_dot2c_f32_bf16_dpp v34, v12, v189 row_newbcast:15 row_mask:0xf bank_mask:0xf
    v_dot2c_f32_bf16_dpp v35, v13, v189 row_newbcast:15 row_mask:0xf bank_mask:0xf
    v_dot2c_f32_bf16_dpp v36, v12, v190 row_newbcast:15 row_mask:0xf bank_mask:0xf
    v_dot2c_f32_bf16_dpp v37, v13, v190 row_newbcast:15 row_mask:0xf bank_mask:0xf
    v_dot2c_f32_bf16_dpp v38, v12, v191 row_newbcast:15 row_mask:0xf bank_mask:0xf
    v_dot2c_f32_bf16_dpp v39, v13, v191 row_newbcast:15 row_mask:0xf bank_mask:0xf
    v_mov_b32 v54, v55
    s_cmp_lt_i32 s31, 0
    s_cbranch_scc0 L_ew57
    s_waitcnt vmcnt(3)
L_ew57:
    s_waitcnt vmcnt(6)
    s_cbranch_vccnz L_ev58
    s_waitcnt vmcnt(4)
L_ev58:
    buffer_load_dwordx4 v[128:131], v1, s[8:11], s16 offen nt
    v_dot2c_f32_bf16_dpp v32, v14, v192 row_newbcast:0 row_mask:0xf bank_mask:0xf
    v_dot2c_f32_bf16_dpp v33, v15, v192 row_newbcast:0 row_mask:0xf bank_mask:0xf
    v_dot2c_f32_bf16_dpp v34, v14, v193 row_newbcast:0 row_mask:0xf bank_mask:0xf
    v_dot2c_f32_bf16_dpp v35, v15, v193 row_newbcast:0 row_mask:0xf bank_mask:0xf
    v_dot2c_f32_bf16_dpp v36, v14, v194 row_newbcast:0 row_mask:0xf bank_mask:0xf
    v_dot2c_f32_bf16_dpp v37, v15, v194 row_newbcast:0 row_mask:0xf bank_mask:0xf
    v_dot2c_f32_bf16_dpp v38, v14, v195 row_newbcast:0 row_mask:0xf bank_mask:0xf
    v_dot2c_f32_bf16_dpp v39, v15, v195 row_newbcast:0 row_mask:0xf bank_mask:0xf
    v_mov_b32 v12, v40
    v_lshlrev_b32 v13, 16, v40
    v_dot2c_f32_bf16_dpp v32, v14, v196 row_newbcast:1 row_mask:0xf bank_mask:0xf
    v_dot2c_f32_bf16_dpp v33, v15, v196 row_newbcast:1 row_mask:0xf bank_mask:0xf
    v_dot2c_f32_bf16_dpp v34, v14, v197 row_newbcast:1 row_mask:0xf bank_mask:0xf
    v_dot2c_f32_bf16_dpp v35, v15, v197 row_newbcast:1 row_mask:0xf bank_mask:0xf
    v_dot2c_f32_bf16_dpp v36, v14, v198 row_newbcast:1 row_mask:0xf bank_mask:0xf
    v_dot2c_f32_bf16_dpp v37, v15, v198 row_newbcast:1 row_mask:0xf bank_mask:0xf
    v_dot2c_f32_bf16_dpp v38, v14, v199 row_newbcast:1 row_mask:0xf bank_mask:0xf
    v_dot2c_f32_bf16_dpp v39, v15, v199 row_newbcast:1 row_mask:0xf bank_mask:0xf
    v_mov_b32 v40, v41
    s_cmp_lt_i32 s31, 0
    s_cbranch_scc0 L_ew58
    s_waitcnt vmcnt(3)
L_ew58:
    s_waitcnt vmcnt(6)
    s_cbranch_vccnz L_ev59
    s_waitcnt vmcnt(4)
L_ev59:
    buffer_load_dwordx4 v[132:135], v1, s[8:11], s16 offen offset:1024 nt
    v_dot2c_f32_bf16_dpp v32, v14, v200 row_newbcast:2 row_mask:0xf bank_mask:0xf
    v_dot2c_f32_bf16_dpp v33, v15, v200 row_newbcast:2 row_mask:0xf bank_mask:0xf
    v_dot2c_f32_bf16_dpp v34, v14, v201 row_newbcast:2 row_mask:0xf bank_mask:0xf
    v_dot2c_f32_bf16_dpp v35, v15, v201 row_newbcast:2 row_mask:0xf bank_mask:0xf
    v_dot2c_f32_bf16_dpp v36, v14, v202 row_newbcast:2 row_mask:0xf bank_mask:0xf
    v_dot2c_f32_bf16_dpp v37, v15, v202 row_newbcast:2 row_mask:0xf bank_mask:0xf
    v_dot2c_f32_bf16_dpp v38, v14, v203 row_newbcast:2 row_mask:0xf bank_mask:0xf
    v_dot2c_f32_bf16_dpp v39, v15, v203 row_newbcast:2 row_mask:0xf bank_mask:0xf
    v_mov_b32 v41, v42
    v_dot2c_f32_bf16_dpp v32, v14, v204 row_newbcast:3 row_mask:0xf bank_mask:0xf
    v_dot2c_f32_bf16_dpp v33, v15, v204 row_newbcast:3 row_mask:0xf bank_mask:0xf
    v_dot2c_f32_bf16_dpp v34, v14, v205 row_newbcast:3 row_mask:0xf bank_mask:0xf
    v_dot2c_f32_bf16_dpp v35, v15, v205 row_newbcast:3 row_mask:0xf bank_mask:0xf
    v_dot2c_f32_bf16_dpp v36, v14, v206 row_newbcast:3 row_mask:0xf bank_mask:0xf
    v_dot2c_f32_bf16_dpp v37, v15, v206 row_newbcast:3 row_mask:0xf bank_mask:0xf
    v_dot2c_f32_bf16_dpp v38, v14, v207 row_newbcast:3 row_mask:0xf bank_mask:0xf
    v_dot2c_f32_bf16_dpp v39, v15, v207 row_newbcast:3 row_mask:0xf bank_mask:0xf
    v_mov_b32 v42, v43
    s_cmp_lt_i32 s31, 0
    s_cbranch_scc0 L_ew59
    s_waitcnt vmcnt(3)
L_ew59:
    s_waitcnt vmcnt(6)
    s_cbranch_vccnz L_ev60
    s_waitcnt vmcnt(4)
L_ev60:
    buffer_load_dwordx4 v[136:139], v1, s[8:11], s16 offen offset:2048 nt
    s_memrealtime s[34:35]
    v_dot2c_f32_bf16_dpp v32, v14, v208 row_newbcast:4 row_mask:0xf bank_mask:0xf
    v_dot2c_f32_bf16_dpp v33, v15, v208 row_newbcast:4 row_mask:0xf bank_mask:0xf
    v_dot2c_f32_bf16_dpp v34, v14, v209 row_newbcast:4 row_mask:0xf bank_mask:0xf
    v_dot2c_f32_bf16_dpp v35, v15, v209 row_newbcast:4 row_mask:0xf bank_mask:0xf
    v_dot2c_f32_bf16_dpp v36, v14, v210 row_newbcast:4 row_mask:0xf bank_mask:0xf
    v_dot2c_f32_bf16_dpp v37, v15, v210 row_newbcast:4 row_mask:0xf bank_mask:0xf
    v_dot2c_f32_bf16_dpp v38, v14, v211 row_newbcast:4 row_mask:0xf bank_mask:0xf
    v_dot2c_f32_bf16_dpp v39, v15, v211 row_newbcast:4 row_mask:0xf bank_mask:0xf
    v_mov_b32 v43, v44
    v_dot2c_f32_bf16_dpp v32, v14, v212 row_newbcast:5 row_mask:0xf bank_mask:0xf
    v_dot2c_f32_bf16_dpp v33, v15, v212 row_newbcast:5 row_mask:0xf bank_mask:0xf
    v_dot2c_f32_bf16_dpp v34, v14, v213 row_newbcast:5 row_mask:0xf bank_mask:0xf
    v_dot2c_f32_bf16_dpp v35, v15, v213 row_newbcast:5 row_mask:0xf bank_mask:0xf
    v_dot2c_f32_bf16_dpp v36, v14, v214 row_newbcast:5 row_mask:0xf bank_mask:0xf
    v_dot2c_f32_bf16_dpp v37, v15, v214 row_newbcast:5 row_mask:0xf bank_mask:0xf
    v_dot2c_f32_bf16_dpp v38, v14, v215 row_newbcast:5 row_mask:0xf bank_mask:0xf
    v_dot2c_f32_bf16_dpp v39, v15, v215 row_newbcast:5 row_mask:0xf bank_mask:0xf
    v_mov_b32 v44, v45
    s_waitcnt lgkmcnt(0)
    s_add_u32 s32, s34, s31
    s_sub_u32 s32, s32, s19
    s_cmp_gt_i32 s32, 0
    s_cselect_b64 vcc, -1, 0
    s_cselect_b32 s31, 27, 0
    s_add_u32 s19, s19, s30
    s_add_u32 s32, s32, s40
    s_cmp_lt_u32 s32, 2000
    s_cselect_b32 s31, -13, s31
    s_cmp_lt_i32 s31, 0
    s_cbranch_scc0 L_ew60
    s_waitcnt vmcnt(3)
L_ew60:
    s_waitcnt vmcnt(6)
    s_cbranch_vccnz L_ev61
    s_waitcnt vmcnt(4)
L_ev61:
    buffer_load_dwordx4 v[140:143], v1, s[8:11], s16 offen offset:3072 nt
    v_dot2c_f32_bf16_dpp v32, v14, v216 row_newbcast:6 row_mask:0xf bank_mask:0xf
    v_dot2c_f32_bf16_dpp v33, v15, v216 row_newbcast:6 row_mask:0xf bank_mask:0xf
    v_dot2c_f32_bf16_dpp v34, v14, v217 row_newbcast:6 row_mask:0xf bank_mask:0xf
    v_dot2c_f32_bf16_dpp v35, v15, v217 row_newbcast:6 row_mask:0xf bank_mask:0xf
    v_dot2c_f32_bf16_dpp v36, v14, v218 row_newbcast:6 row_mask:0xf bank_mask:0xf
    v_dot2c_f32_bf16_dpp v37, v15, v218 row_newbcast:6 row_mask:0xf bank_mask:0xf
    v_dot2c_f32_bf16_dpp v38, v14, v219 row_newbcast:6 row_mask:0xf bank_mask:0xf
    v_dot2c_f32_bf16_dpp v39, v15, v219 row_newbcast:6 row_mask:0xf bank_mask:0xf
    v_mov_b32 v45, v46
    v_dot2c_f32_bf16_dpp v32, v14, v220 row_newbcast:7 row_mask:0xf bank_mask:0xf
    v_dot2c_f32_bf16_dpp v33, v15, v220 row_newbcast:7 row_mask:0xf bank_mask:0xf
    v_dot2c_f32_bf16_dpp v34, v14, v221 row_newbcast:7 row_mask:0xf bank_mask:0xf
    v_dot2c_f32_bf16_dpp v35, v15, v221 row_newbcast:7 row_mask:0xf bank_mask:0xf
    v_dot2c_f32_bf16_dpp v36, v14, v222 row_newbcast:7 row_mask:0xf bank_mask:0xf
    v_dot2c_f32_bf16_dpp v37, v15, v222 row_newbcast:7 row_mask:0xf bank_mask:0xf
    v_dot2c_f32_bf16_dpp v38, v14, v223 row_newbcast:7 row_mask:0xf bank_mask:0xf
    v_dot2c_f32_bf16_dpp v39, v15, v223 row_newbcast:7 row_mask:0xf bank_mask:0xf
    v_mov_b32 v46, v47
    v_dot2c_f32_bf16_dpp v32, v14, v224 row_newbcast:8 row_mask:0xf bank_mask:0xf
    v_dot2c_f32_bf16_dpp v33, v15, v224 row_newbcast:8 row_mask:0xf bank_mask:0xf
    v_dot2c_f32_bf16_dpp v34, v14, v225 row_newbcast:8 row_mask:0xf bank_mask:0xf
    v_dot2c_f32_bf16_dpp v35, v15, v225 row_newbcast:8 row_mask:0xf bank_mask:0xf
    v_dot2c_f32_bf16_dpp v36, v14, v226 row_newbcast:8 row_mask:0xf bank_mask:0xf
    v_dot2c_f32_bf16_dpp v37, v15, v226 row_newbcast:8 row_mask:0xf bank_mask:0xf
    v_dot2c_f32_bf16_dpp v38, v14, v227 row_newbcast:8 row_mask:0xf bank_mask:0xf
    v_dot2c_f32_bf16_dpp v39, v15, v227 row_newbcast:8 row_mask:0xf bank_mask:0xf
    v_mov_b32 v47, v48
    s_cmp_lt_i32 s31, 0
    s_cbranch_scc0 L_ew61
    s_waitcnt vmcnt(3)
L_ew61:
    s_waitcnt vmcnt(6)
    s_cbranch_vccnz L_ev62
    s_waitcnt vmcnt(4)
L_ev62:
    buffer_load_dwordx4 v[144:147], v2, s[8:11], s16 offen nt
    v_dot2c_f32_bf16_dpp v32, v14, v228 row_newbcast:9 row_mask:0xf bank_mask:0xf
    v_dot2c_f32_bf16_dpp v33, v15, v228 row_newbcast:9 row_mask:0xf bank_mask:0xf
    v_dot2c_f32_bf16_dpp v34, v14, v229 row_newbcast:9 row_mask:0xf bank_mask:0xf
    v_dot2c_f32_bf16_dpp v35, v15, v229 row_newbcast:9 row_mask:0xf bank_mask:0xf
    v_dot2c_f32_bf16_dpp v36, v14, v230 row_newbcast:9 row_mask:0xf bank_mask:0xf
    v_dot2c_f32_bf16_dpp v37, v15, v230 row_newbcast:9 row_mask:0xf bank_mask:0xf
    v_dot2c_f32_bf16_dpp v38, v14, v231 row_newbcast:9 row_mask:0xf bank_mask:0xf
    v_dot2c_f32_bf16_dpp v39, v15, v231 row_newbcast:9 row_mask:0xf bank_mask:0xf
    v_mov_b32 v48, v49
    v_dot2c_f32_bf16_dpp v32, v14, v232 row_newbcast:10 row_mask:0xf bank_mask:0xf
    v_dot2c_f32_bf16_dpp v33, v15, v232 row_newbcast:10 row_mask:0xf bank_mask:0xf
    v_dot2c_f32_bf16_dpp v34, v14, v233 row_newbcast:10 row_mask:0xf bank_mask:0xf
    v_dot2c_f32_bf16_dpp v35, v15, v233 row_newbcast:10 row_mask:0xf bank_mask:0xf
    v_dot2c_f32_bf16_dpp v36, v14, v234 row_newbcast:10 row_mask:0xf bank_mask:0xf
    v_dot2c_f32_bf16_dpp v37, v15, v234 row_newbcast:10 row_mask:0xf bank_mask:0xf
    v_dot2c_f32_bf16_dpp v38, v14, v235 row_newbcast:10 row_mask:0xf bank_mask:0xf
    v_dot2c_f32_bf16_dpp v39, v15, v235 row_newbcast:10 row_mask:0xf bank_mask:0xf
    v_mov_b32 v49, v50
    s_cmp_lt_i32 s31, 0
    s_cbranch_scc0 L_ew62
    s_waitcnt vmcnt(3)
L_ew62:
    s_waitcnt vmcnt(6)
    s_cbranch_vccnz L_ev63
    s_waitcnt vmcnt(4)
L_ev63:
    buffer_load_dwordx4 v[148:151], v2, s[8:11], s16 offen offset:1024 nt
    v_dot2c_f32_bf16_dpp v32, v14, v236 row_newbcast:11 row_mask:0xf bank_mask:0xf
    v_dot2c_f32_bf16_dpp v33, v15, v236 row_newbcast:11 row_mask:0xf bank_mask:0xf
    v_dot2c_f32_bf16_dpp v34, v14, v237 row_newbcast:11 row_mask:0xf bank_mask:0xf
    v_dot2c_f32_bf16_dpp v35, v15, v237 row_newbcast:11 row_mask:0xf bank_mask:0xf
    v_dot2c_f32_bf16_dpp v36, v14, v238 row_newbcast:11 row_mask:0xf bank_mask:0xf
    v_dot2c_f32_bf16_dpp v37, v15, v238 row_newbcast:11 row_mask:0xf bank_mask:0xf
    v_dot2c_f32_bf16_dpp v38, v14, v239 row_newbcast:11 row_mask:0xf bank_mask:0xf
    v_dot2c_f32_bf16_dpp v39, v15, v239 row_newbcast:11 row_mask:0xf bank_mask:0xf
    v_mov_b32 v50, v51
    v_dot2c_f32_bf16_dpp v32, v14, v240 row_newbcast:12 row_mask:0xf bank_mask:0xf
    v_dot2c_f32_bf16_dpp v33, v15, v240 row_newbcast:12 row_mask:0xf bank_mask:0xf
    v_dot2c_f32_bf16_dpp v34, v14, v241 row_newbcast:12 row_mask:0xf bank_mask:0xf
    v_dot2c_f32_bf16_dpp v35, v15, v241 row_newbcast:12 row_mask:0xf bank_mask:0xf
    v_dot2c_f32_bf16_dpp v36, v14, v242 row_newbcast:12 row_mask:0xf bank_mask:0xf
    v_dot2c_f32_bf16_dpp v37, v15, v242 row_newbcast:12 row_mask:0xf bank_mask:0xf
    v_dot2c_f32_bf16_dpp v38, v14, v243 row_newbcast:12 row_mask:0xf bank_mask:0xf
    v_dot2c_f32_bf16_dpp v39, v15, v243 row_newbcast:12 row_mask:0xf bank_mask:0xf
    v_mov_b32 v51, v52
    s_cmp_lt_i32 s31, 0
    s_cbranch_scc0 L_ew63
    s_waitcnt vmcnt(3)
L_ew63:
    s_waitcnt vmcnt(6)
    s_cbranch_vccnz L_ev64
    s_waitcnt vmcnt(4)
L_ev64:
    buffer_load_dwordx4 v[152:155], v2, s[8:11], s16 offen offset:2048 nt
    s_memrealtime s[34:35]
    v_dot2c_f32_bf16_dpp v32, v14, v244 row_newbcast:13 row_mask:0xf bank_mask:0xf
    v_dot2c_f32_bf16_dpp v33, v15, v244 row_newbcast:13 row_mask:0xf bank_mask:0xf
    v_dot2c_f32_bf16_dpp v34, v14, v245 row_newbcast:13 row_mask:0xf bank_mask:0xf
    v_dot2c_f32_bf16_dpp v35, v15, v245 row_newbcast:13 row_mask:0xf bank_mask:0xf
    v_dot2c_f32_bf16_dpp v36, v14, v246 row_newbcast:13 row_mask:0xf bank_mask:0xf
    v_dot2c_f32_bf16_dpp v37, v15, v246 row_newbcast:13 row_mask:0xf bank_mask:0xf
    v_dot2c_f32_bf16_dpp v38, v14, v247 row_newbcast:13 row_mask:0xf bank_mask:0xf
    v_dot2c_f32_bf16_dpp v39, v15, v247 row_newbcast:13 row_mask:0xf bank_mask:0xf
    v_mov_b32 v52, v53
    v_dot2c_f32_bf16_dpp v32, v14, v248 row_newbcast:14 row_mask:0xf bank_mask:0xf
    v_dot2c_f32_bf16_dpp v33, v15, v248 row_newbcast:14 row_mask:0xf bank_mask:0xf
    v_dot2c_f32_bf16_dpp v34, v14, v249 row_newbcast:14 row_mask:0xf bank_mask:0xf
    v_dot2c_f32_bf16_dpp v35, v15, v249 row_newbcast:14 row_mask:0xf bank_mask:0xf
    v_dot2c_f32_bf16_dpp v36, v14, v250 row_newbcast:14 row_mask:0xf bank_mask:0xf
    v_dot2c_f32_bf16_dpp v37, v15, v250 row_newbcast:14 row_mask:0xf bank_mask:0xf
    v_dot2c_f32_bf16_dpp v38, v14, v251 row_newbcast:14 row_mask:0xf bank_mask:0xf
    v_dot2c_f32_bf16_dpp v39, v15, v251 row_newbcast:14 row_mask:0xf bank_mask:0xf
    v_mov_b32 v53, v54
    v_dot2c_f32_bf16_dpp v32, v14, v252 row_newbcast:15 row_mask:0xf bank_mask:0xf
    v_dot2c_f32_bf16_dpp v33, v15, v252 row_newbcast:15 row_mask:0xf bank_mask:0xf
    v_dot2c_f32_bf16_dpp v34, v14, v253 row_newbcast:15 row_mask:0xf bank_mask:0xf
    v_dot2c_f32_bf16_dpp v35, v15, v253 row_newbcast:15 row_mask:0xf bank_mask:0xf
    v_dot2c_f32_bf16_dpp v36, v14, v254 row_newbcast:15 row_mask:0xf bank_mask:0xf
    v_dot2c_f32_bf16_dpp v37, v15, v254 row_newbcast:15 row_mask:0xf bank_mask:0xf
    v_dot2c_f32_bf16_dpp v38, v14, v255 row_newbcast:15 row_mask:0xf bank_mask:0xf
    v_dot2c_f32_bf16_dpp v39, v15, v255 row_newbcast:15 row_mask:0xf bank_mask:0xf
    v_mov_b32 v54, v55
    s_mov_b32 s18, 9
.p2align 6
L_vloop:
    s_waitcnt lgkmcnt(0)
    s_add_u32 s32, s34, s31
    v_mov_b32 v63, s18
    v_mov_b32 v62, s32
    ds_write_b64 v57, v[62:63] offset:4272
    s_add_u32 s32, s34, s31
    s_sub_u32 s32, s32, s19
    s_cmp_gt_i32 s32, 0
    s_cselect_b64 vcc, -1, 0
    s_cselect_b32 s31, 27, 0
    s_add_u32 s19, s19, s30
    s_add_u32 s32, s32, s40
    s_cmp_lt_u32 s32, 2000
    s_cselect_b32 s31, -13, s31
    s_cmp_lt_i32 s31, 0
    s_cbranch_scc0 L_ew64
    s_waitcnt vmcnt(3)
L_ew64:
    s_waitcnt vmcnt(6)
    s_cbranch_vccnz L_ev65
    s_waitcnt vmcnt(4)
L_ev65:
    buffer_load_dwordx4 v[156:159], v2, s[8:11], s16 offen offset:3072 nt
    s_add_u32 s50, s50, 1
    s_sub_u32 s51, s50, s42
    s_cmp_le_u32 s51, 2
    s_cbranch_scc0 L_xr3
    s_cmp_eq_u32 s51, 1
    s_cbranch_scc0 L_xa3
    s_cmp_eq_u32 s43, 0
    s_cbranch_scc1 L_xr3
    v_lshrrev_b32 v12, 16, v112
    v_and_b32 v13, s26, v112
    s_nop 0
    s_branch L_xr3
L_xa3:
    v_swap_b32 v32, v116
    v_swap_b32 v33, v117
    v_swap_b32 v34, v118
    v_swap_b32 v35, v119
    v_swap_b32 v36, v120
    v_swap_b32 v37, v121
    v_swap_b32 v38, v122
    v_swap_b32 v39, v123
    s_cmp_eq_u32 s51, 0
    s_cbranch_scc0 L_xo3
    s_cmp_eq_u32 s43, 0
    s_cbranch_scc1 L_xr3
L_xw3:
    ds_read_b32 v127, v56 offset:240
    ds_read_b32 v112, v125 offset:9216
    s_waitcnt lgkmcnt(0)
    v_readfirstlane_b32 s33, v127
    v_and_b32 v12, 0xffff, v112
    v_lshlrev_b32 v13, 16, v112
    s_cmp_lt_u32 s33, 3
    s_cbranch_scc1 L_xw3
    s_branch L_xr3
L_xo3:
    v_permlane32_swap_b32 v116, v120
    v_permlane32_swap_b32 v117, v121
    v_permlane32_swap_b32 v118, v122
    v_permlane32_swap_b32 v119, v123
    v_add_f32 v116, v116, v120
    v_add_f32 v117, v117, v121
    v_add_f32 v118, v118, v122
    v_add_f32 v119, v119, v123
    s_nop 0
    v_permlane16_swap_b32 v116, v118
    v_permlane16_swap_b32 v117, v119
    v_add_f32 v116, v116, v118
    v_add_f32 v117, v117, v119
    ds_write_b64 v126, v[116:117] offset:11776
    v_mov_b32 v127, 3
    ds_write_b32 v124, v127 offset:4320
L_xr3:
    v_dot2c_f32_bf16_dpp v32, v12, v128 row_newbcast:0 row_mask:0xf bank_mask:0xf
    v_dot2c_f32_bf16_dpp v33, v13, v128 row_newbcast:0 row_mask:0xf bank_mask:0xf
    v_dot2c_f32_bf16_dpp v34, v12, v129 row_newbcast:0 row_mask:0xf bank_mask:0xf
    v_dot2c_f32_bf16_dpp v35, v13, v129 row_newbcast:0 row_mask:0xf bank_mask:0xf
    v_dot2c_f32_bf16_dpp v36, v12, v130 row_newbcast:0 row_mask:0xf bank_mask:0xf
    v_dot2c_f32_bf16_dpp v37, v13, v130 row_newbcast:0 row_mask:0xf bank_mask:0xf
    v_dot2c_f32_bf16_dpp v38, v12, v131 row_newbcast:0 row_mask:0xf bank_mask:0xf
    v_dot2c_f32_bf16_dpp v39, v13, v131 row_newbcast:0 row_mask:0xf bank_mask:0xf
    v_mov_b32 v14, v40
    v_lshlrev_b32 v15, 16, v40
    s_cmp_lt_i32 s31, 0
    s_cbranch_scc0 L_ew65
    s_waitcnt vmcnt(3)
L_ew65:
    s_waitcnt vmcnt(6)
    s_cbranch_vccnz L_ev66
    s_waitcnt vmcnt(4)
L_ev66:
    buffer_load_dwordx4 v[160:163], v3, s[8:11], s16 offen nt
    v_dot2c_f32_bf16_dpp v32, v12, v132 row_newbcast:1 row_mask:0xf bank_mask:0xf
    v_dot2c_f32_bf16_dpp v33, v13, v132 row_newbcast:1 row_mask:0xf bank_mask:0xf
    v_dot2c_f32_bf16_dpp v34, v12, v133 row_newbcast:1 row_mask:0xf bank_mask:0xf
    v_dot2c_f32_bf16_dpp v35, v13, v133 row_newbcast:1 row_mask:0xf bank_mask:0xf
    v_dot2c_f32_bf16_dpp v36, v12, v134 row_newbcast:1 row_mask:0xf bank_mask:0xf
    v_dot2c_f32_bf16_dpp v37, v13, v134 row_newbcast:1 row_mask:0xf bank_mask:0xf
    v_dot2c_f32_bf16_dpp v38, v12, v135 row_newbcast:1 row_mask:0xf bank_mask:0xf
    v_dot2c_f32_bf16_dpp v39, v13, v135 row_newbcast:1 row_mask:0xf bank_mask:0xf
    v_mov_b32 v40, v41
    s_cmp_lt_i32 s31, 0
    s_cbranch_scc0 L_ew66
    s_waitcnt vmcnt(3)
L_ew66:
    s_waitcnt vmcnt(6)
    s_cbranch_vccnz L_ev67
    s_waitcnt vmcnt(4)
L_ev67:
    buffer_load_dwordx4 v[164:167], v3, s[8:11], s16 offen offset:1024 nt
    v_dot2c_f32_bf16_dpp v32, v12, v136 row_newbcast:2 row_mask:0xf bank_mask:0xf
    v_dot2c_f32_bf16_dpp v33, v13, v136 row_newbcast:2 row_mask:0xf bank_mask:0xf
    v_dot2c_f32_bf16_dpp v34, v12, v137 row_newbcast:2 row_mask:0xf bank_mask:0xf
    v_dot2c_f32_bf16_dpp v35, v13, v137 row_newbcast:2 row_mask:0xf bank_mask:0xf
    v_dot2c_f32_bf16_dpp v36, v12, v138 row_newbcast:2 row_mask:0xf bank_mask:0xf
    v_dot2c_f32_bf16_dpp v37, v13, v138 row_newbcast:2 row_mask:0xf bank_mask:0xf
    v_dot2c_f32_bf16_dpp v38, v12, v139 row_newbcast:2 row_mask:0xf bank_mask:0xf
    v_dot2c_f32_bf16_dpp v39, v13, v139 row_newbcast:2 row_mask:0xf bank_mask:0xf
    v_mov_b32 v41, v42
    s_cmp_lt_i32 s31, 0
    s_cbranch_scc0 L_ew67
    s_waitcnt vmcnt(3)
L_ew67:
    s_waitcnt vmcnt(6)
    s_cbranch_vccnz L_ev68
    s_waitcnt vmcnt(4)
L_ev68:
    buffer_load_dwordx4 v[168:171], v3, s[8:11], s16 offen offset:2048 nt
    s_memrealtime s[34:35]
    v_dot2c_f32_bf16_dpp v32, v12, v140 row_newbcast:3 row_mask:0xf bank_mask:0xf
    v_dot2c_f32_bf16_dpp v33, v13, v140 row_newbcast:3 row_mask:0xf bank_mask:0xf
    v_dot2c_f32_bf16_dpp v34, v12, v141 row_newbcast:3 row_mask:0xf bank_mask:0xf
    v_dot2c_f32_bf16_dpp v35, v13, v141 row_newbcast:3 row_mask:0xf bank_mask:0xf
    v_dot2c_f32_bf16_dpp v36, v12, v142 row_newbcast:3 row_mask:0xf bank_mask:0xf
    v_dot2c_f32_bf16_dpp v37, v13, v142 row_newbcast:3 row_mask:0xf bank_mask:0xf
    v_dot2c_f32_bf16_dpp v38, v12, v143 row_newbcast:3 row_mask:0xf bank_mask:0xf
    v_dot2c_f32_bf16_dpp v39, v13, v143 row_newbcast:3 row_mask:0xf bank_mask:0xf
    v_mov_b32 v42, v43
    s_waitcnt lgkmcnt(0)
    s_add_u32 s32, s34, s31
    s_sub_u32 s32, s32, s19
    s_cmp_gt_i32 s32, 0
    s_cselect_b64 vcc, -1, 0
    s_cselect_b32 s31, 27, 0
    s_add_u32 s19, s19, s30
    s_add_u32 s32, s32, s40
    s_cmp_lt_u32 s32, 2000
    s_cselect_b32 s31, -13, s31
    s_cmp_lt_i32 s31, 0
    s_cbranch_scc0 L_ew68
    s_waitcnt vmcnt(3)
L_ew68:
    s_waitcnt vmcnt(6)
    s_cbranch_vccnz L_ev69
    s_waitcnt vmcnt(4)
L_ev69:
    buffer_load_dwordx4 v[172:175], v3, s[8:11], s16 offen offset:3072 nt
    v_dot2c_f32_bf16_dpp v32, v12, v144 row_newbcast:4 row_mask:0xf bank_mask:0xf
    v_dot2c_f32_bf16_dpp v33, v13, v144 row_newbcast:4 row_mask:0xf bank_mask:0xf
    v_dot2c_f32_bf16_dpp v34, v12, v145 row_newbcast:4 row_mask:0xf bank_mask:0xf
    v_dot2c_f32_bf16_dpp v35, v13, v145 row_newbcast:4 row_mask:0xf bank_mask:0xf
    v_dot2c_f32_bf16_dpp v36, v12, v146 row_newbcast:4 row_mask:0xf bank_mask:0xf
    v_dot2c_f32_bf16_dpp v37, v13, v146 row_newbcast:4 row_mask:0xf bank_mask:0xf
    v_dot2c_f32_bf16_dpp v38, v12, v147 row_newbcast:4 row_mask:0xf bank_mask:0xf
    v_dot2c_f32_bf16_dpp v39, v13, v147 row_newbcast:4 row_mask:0xf bank_mask:0xf
    v_mov_b32 v43, v44
    s_cmp_lt_i32 s31, 0
    s_cbranch_scc0 L_ew69
    s_waitcnt vmcnt(3)
L_ew69:
    s_waitcnt vmcnt(6)
    s_cbranch_vccnz L_ev70
    s_waitcnt vmcnt(4)
L_ev70:
    buffer_load_dwordx4 v[176:179], v4, s[8:11], s16 offen nt
    v_dot2c_f32_bf16_dpp v32, v12, v148 row_newbcast:5 row_mask:0xf bank_mask:0xf
    v_dot2c_f32_bf16_dpp v33, v13, v148 row_newbcast:5 row_mask:0xf bank_mask:0xf
    v_dot2c_f32_bf16_dpp v34, v12, v149 row_newbcast:5 row_mask:0xf bank_mask:0xf
    v_dot2c_f32_bf16_dpp v35, v13, v149 row_newbcast:5 row_mask:0xf bank_mask:0xf
    v_dot2c_f32_bf16_dpp v36, v12, v150 row_newbcast:5 row_mask:0xf bank_mask:0xf
    v_dot2c_f32_bf16_dpp v37, v13, v150 row_newbcast:5 row_mask:0xf bank_mask:0xf
    v_dot2c_f32_bf16_dpp v38, v12, v151 row_newbcast:5 row_mask:0xf bank_mask:0xf
    v_dot2c_f32_bf16_dpp v39, v13, v151 row_newbcast:5 row_mask:0xf bank_mask:0xf
    v_mov_b32 v44, v45
    s_cmp_lt_i32 s31, 0
    s_cbranch_scc0 L_ew70
    s_waitcnt vmcnt(3)
L_ew70:
    s_waitcnt vmcnt(6)
    s_cbranch_vccnz L_ev71
    s_waitcnt vmcnt(4)
L_ev71:
    buffer_load_dwordx4 v[180:183], v4, s[8:11], s16 offen offset:1024 nt
    v_dot2c_f32_bf16_dpp v32, v12, v152 row_newbcast:6 row_mask:0xf bank_mask:0xf
    v_dot2c_f32_bf16_dpp v33, v13, v152 row_newbcast:6 row_mask:0xf bank_mask:0xf
    v_dot2c_f32_bf16_dpp v34, v12, v153 row_newbcast:6 row_mask:0xf bank_mask:0xf
    v_dot2c_f32_bf16_dpp v35, v13, v153 row_newbcast:6 row_mask:0xf bank_mask:0xf
    v_dot2c_f32_bf16_dpp v36, v12, v154 row_newbcast:6 row_mask:0xf bank_mask:0xf
    v_dot2c_f32_bf16_dpp v37, v13, v154 row_newbcast:6 row_mask:0xf bank_mask:0xf
    v_dot2c_f32_bf16_dpp v38, v12, v155 row_newbcast:6 row_mask:0xf bank_mask:0xf
    v_dot2c_f32_bf16_dpp v39, v13, v155 row_newbcast:6 row_mask:0xf bank_mask:0xf
    v_mov_b32 v45, v46
    s_cmp_lt_i32 s31, 0
    s_cbranch_scc0 L_ew71
    s_waitcnt vmcnt(3)
L_ew71:
    s_waitcnt vmcnt(6)
    s_cbranch_vccnz L_ev72
    s_waitcnt vmcnt(4)
L_ev72:
    buffer_load_dwordx4 v[184:187], v4, s[8:11], s16 offen offset:2048 nt
    s_memrealtime s[34:35]
    v_dot2c_f32_bf16_dpp v32, v12, v156 row_newbcast:7 row_mask:0xf bank_mask:0xf
    v_dot2c_f32_bf16_dpp v33, v13, v156 row_newbcast:7 row_mask:0xf bank_mask:0xf
    v_dot2c_f32_bf16_dpp v34, v12, v157 row_newbcast:7 row_mask:0xf bank_mask:0xf
    v_dot2c_f32_bf16_dpp v35, v13, v157 row_newbcast:7 row_mask:0xf bank_mask:0xf
    v_dot2c_f32_bf16_dpp v36, v12, v158 row_newbcast:7 row_mask:0xf bank_mask:0xf
    v_dot2c_f32_bf16_dpp v37, v13, v158 row_newbcast:7 row_mask:0xf bank_mask:0xf
    v_dot2c_f32_bf16_dpp v38, v12, v159 row_newbcast:7 row_mask:0xf bank_mask:0xf
    v_dot2c_f32_bf16_dpp v39, v13, v159 row_newbcast:7 row_mask:0xf bank_mask:0xf
    v_mov_b32 v46, v47
    s_waitcnt lgkmcnt(0)
    s_add_u32 s32, s34, s31
    s_sub_u32 s32, s32, s19
    s_cmp_gt_i32 s32, 0
    s_cselect_b64 vcc, -1, 0
    s_cselect_b32 s31, 27, 0
    s_add_u32 s19, s19, s30
    s_add_u32 s32, s32, s40
    s_cmp_lt_u32 s32, 2000
    s_cselect_b32 s31, -13, s31
    s_cmp_lt_i32 s31, 0
    s_cbranch_scc0 L_ew72
    s_waitcnt vmcnt(3)
L_ew72:
    s_waitcnt vmcnt(6)
    s_cbranch_vccnz L_ev73
    s_waitcnt vmcnt(4)
L_ev73:
    buffer_load_dwordx4 v[188:191], v4, s[8:11], s16 offen offset:3072 nt
    s_add_u32 s14, s14, 0x20000
    s_and_b32 s16, s14, 0xe0000
    s_lshr_b32 s27, s14, 6
    s_and_b32 s27, s27, 0x4000
    s_or_b32 s16, s16, s27
    s_xor_b32 s16, s16, s15
    s_add_u32 s41, s41, 1
    s_sub_u32 s27, s41, s42
    s_cmp_lt_u32 s27, 2
    s_cselect_b32 s27, s43, 0
    s_xor_b32 s16, s16, s27
    v_dot2c_f32_bf16_dpp v32, v12, v160 row_newbcast:8 row_mask:0xf bank_mask:0xf
    v_dot2c_f32_bf16_dpp v33, v13, v160 row_newbcast:8 row_mask:0xf bank_mask:0xf
    v_dot2c_f32_bf16_dpp v34, v12, v161 row_newbcast:8 row_mask:0xf bank_mask:0xf
    v_dot2c_f32_bf16_dpp v35, v13, v161 row_newbcast:8 row_mask:0xf bank_mask:0xf
    v_dot2c_f32_bf16_dpp v36, v12, v162 row_newbcast:8 row_mask:0xf bank_mask:0xf
    v_dot2c_f32_bf16_dpp v37, v13, v162 row_newbcast:8 row_mask:0xf bank_mask:0xf
    v_dot2c_f32_bf16_dpp v38, v12, v163 row_newbcast:8 row_mask:0xf bank_mask:0xf
    v_dot2c_f32_bf16_dpp v39, v13, v163 row_newbcast:8 row_mask:0xf bank_mask:0xf
    v_mov_b32 v47, v48
    s_cmp_lt_i32 s31, 0
    s_cbranch_scc0 L_ew73
    s_waitcnt vmcnt(3)
L_ew73:
    s_waitcnt vmcnt(6)
    s_cbranch_vccnz L_ev74
    s_waitcnt vmcnt(4)
L_ev74:
    buffer_load_dwordx4 v[192:195], v1, s[8:11], s16 offen nt
    v_dot2c_f32_bf16_dpp v32, v12, v164 row_newbcast:9 row_mask:0xf bank_mask:0xf
    v_dot2c_f32_bf16_dpp v33, v13, v164 row_newbcast:9 row_mask:0xf bank_mask:0xf
    v_dot2c_f32_bf16_dpp v34, v12, v165 row_newbcast:9 row_mask:0xf bank_mask:0xf
    v_dot2c_f32_bf16_dpp v35, v13, v165 row_newbcast:9 row_mask:0xf bank_mask:0xf
    v_dot2c_f32_bf16_dpp v36, v12, v166 row_newbcast:9 row_mask:0xf bank_mask:0xf
    v_dot2c_f32_bf16_dpp v37, v13, v166 row_newbcast:9 row_mask:0xf bank_mask:0xf
    v_dot2c_f32_bf16_dpp v38, v12, v167 row_newbcast:9 row_mask:0xf bank_mask:0xf
    v_dot2c_f32_bf16_dpp v39, v13, v167 row_newbcast:9 row_mask:0xf bank_mask:0xf
    v_mov_b32 v48, v49
    s_cmp_lt_i32 s31, 0
    s_cbranch_scc0 L_ew74
    s_waitcnt vmcnt(3)
L_ew74:
    s_waitcnt vmcnt(6)
    s_cbranch_vccnz L_ev75
    s_waitcnt vmcnt(4)
L_ev75:
    buffer_load_dwordx4 v[196:199], v1, s[8:11], s16 offen offset:1024 nt
    v_dot2c_f32_bf16_dpp v32, v12, v168 row_newbcast:10 row_mask:0xf bank_mask:0xf
    v_dot2c_f32_bf16_dpp v33, v13, v168 row_newbcast:10 row_mask:0xf bank_mask:0xf
    v_dot2c_f32_bf16_dpp v34, v12, v169 row_newbcast:10 row_mask:0xf bank_mask:0xf
    v_dot2c_f32_bf16_dpp v35, v13, v169 row_newbcast:10 row_mask:0xf bank_mask:0xf
    v_dot2c_f32_bf16_dpp v36, v12, v170 row_newbcast:10 row_mask:0xf bank_mask:0xf
    v_dot2c_f32_bf16_dpp v37, v13, v170 row_newbcast:10 row_mask:0xf bank_mask:0xf
    v_dot2c_f32_bf16_dpp v38, v12, v171 row_newbcast:10 row_mask:0xf bank_mask:0xf
    v_dot2c_f32_bf16_dpp v39, v13, v171 row_newbcast:10 row_mask:0xf bank_mask:0xf
    v_mov_b32 v49, v50
    ds_read_b96 v[58:60], v56 offset:128
    ds_read_b32 v0, v56 offset:140
    s_cmp_lt_i32 s31, 0
    s_cbranch_scc0 L_ew75
    s_waitcnt vmcnt(3)
L_ew75:
    s_waitcnt vmcnt(6)
    s_cbranch_vccnz L_ev76
    s_waitcnt vmcnt(4)
L_ev76:
    buffer_load_dwordx4 v[200:203], v1, s[8:11], s16 offen offset:2048 nt
    s_memrealtime s[34:35]
    v_dot2c_f32_bf16_dpp v32, v12, v172 row_newbcast:11 row_mask:0xf bank_mask:0xf
    v_dot2c_f32_bf16_dpp v33, v13, v172 row_newbcast:11 row_mask:0xf bank_mask:0xf
    v_dot2c_f32_bf16_dpp v34, v12, v173 row_newbcast:11 row_mask:0xf bank_mask:0xf
    v_dot2c_f32_bf16_dpp v35, v13, v173 row_newbcast:11 row_mask:0xf bank_mask:0xf
    v_dot2c_f32_bf16_dpp v36, v12, v174 row_newbcast:11 row_mask:0xf bank_mask:0xf
    v_dot2c_f32_bf16_dpp v37, v13, v174 row_newbcast:11 row_mask:0xf bank_mask:0xf
    v_dot2c_f32_bf16_dpp v38, v12, v175 row_newbcast:11 row_mask:0xf bank_mask:0xf
    v_dot2c_f32_bf16_dpp v39, v13, v175 row_newbcast:11 row_mask:0xf bank_mask:0xf
    v_mov_b32 v50, v51
    s_waitcnt lgkmcnt(0)
    v_readfirstlane_b32 s32, v60
    v_readfirstlane_b32 s33, v58
    v_readfirstlane_b32 s36, v59
    v_readfirstlane_b32 s40, v0
    s_cmp_eq_u32 s32, s18
    s_cselect_b32 s19, s33, s19
    s_cselect_b32 s30, s36, s30
    s_add_u32 s32, s34, s31
    s_sub_u32 s32, s32, s19
    s_cmp_gt_i32 s32, 0
    s_cselect_b64 vcc, -1, 0
    s_cselect_b32 s31, 27, 0
    s_add_u32 s19, s19, s30
    s_add_u32 s32, s32, s40
    s_cmp_lt_u32 s32, 2000
    s_cselect_b32 s31, -13, s31
    s_cmp_lt_i32 s31, 0
    s_cbranch_scc0 L_ew76
    s_waitcnt vmcnt(3)
L_ew76:
    s_waitcnt vmcnt(6)
    s_cbranch_vccnz L_ev77
    s_waitcnt vmcnt(4)
L_ev77:
    buffer_load_dwordx4 v[204:207], v1, s[8:11], s16 offen offset:3072 nt
    v_dot2c_f32_bf16_dpp v32, v12, v176 row_newbcast:12 row_mask:0xf bank_mask:0xf
    v_dot2c_f32_bf16_dpp v33, v13, v176 row_newbcast:12 row_mask:0xf bank_mask:0xf
    v_dot2c_f32_bf16_dpp v34, v12, v177 row_newbcast:12 row_mask:0xf bank_mask:0xf
    v_dot2c_f32_bf16_dpp v35, v13, v177 row_newbcast:12 row_mask:0xf bank_mask:0xf
    v_dot2c_f32_bf16_dpp v36, v12, v178 row_newbcast:12 row_mask:0xf bank_mask:0xf
    v_dot2c_f32_bf16_dpp v37, v13, v178 row_newbcast:12 row_mask:0xf bank_mask:0xf
    v_dot2c_f32_bf16_dpp v38, v12, v179 row_newbcast:12 row_mask:0xf bank_mask:0xf
    v_dot2c_f32_bf16_dpp v39, v13, v179 row_newbcast:12 row_mask:0xf bank_mask:0xf
    v_mov_b32 v51, v52
    s_cmp_lt_i32 s31, 0
    s_cbranch_scc0 L_ew77
    s_waitcnt vmcnt(3)
L_ew77:
    s_waitcnt vmcnt(6)
    s_cbranch_vccnz L_ev78
    s_waitcnt vmcnt(4)
L_ev78:
    buffer_load_dwordx4 v[208:211], v2, s[8:11], s16 offen nt
    v_dot2c_f32_bf16_dpp v32, v12, v180 row_newbcast:13 row_mask:0xf bank_mask:0xf
    v_dot2c_f32_bf16_dpp v33, v13, v180 row_newbcast:13 row_mask:0xf bank_mask:0xf
    v_dot2c_f32_bf16_dpp v34, v12, v181 row_newbcast:13 row_mask:0xf bank_mask:0xf
    v_dot2c_f32_bf16_dpp v35, v13, v181 row_newbcast:13 row_mask:0xf bank_mask:0xf
    v_dot2c_f32_bf16_dpp v36, v12, v182 row_newbcast:13 row_mask:0xf bank_mask:0xf
    v_dot2c_f32_bf16_dpp v37, v13, v182 row_newbcast:13 row_mask:0xf bank_mask:0xf
    v_dot2c_f32_bf16_dpp v38, v12, v183 row_newbcast:13 row_mask:0xf bank_mask:0xf
    v_dot2c_f32_bf16_dpp v39, v13, v183 row_newbcast:13 row_mask:0xf bank_mask:0xf
    v_mov_b32 v52, v53
    s_cmp_lt_i32 s31, 0
    s_cbranch_scc0 L_ew78
    s_waitcnt vmcnt(3)
L_ew78:
    s_waitcnt vmcnt(6)
    s_cbranch_vccnz L_ev79
    s_waitcnt vmcnt(4)
L_ev79:
    buffer_load_dwordx4 v[212:215], v2, s[8:11], s16 offen offset:1024 nt
    v_dot2c_f32_bf16_dpp v32, v12, v184 row_newbcast:14 row_mask:0xf bank_mask:0xf
    v_dot2c_f32_bf16_dpp v33, v13, v184 row_newbcast:14 row_mask:0xf bank_mask:0xf
    v_dot2c_f32_bf16_dpp v34, v12, v185 row_newbcast:14 row_mask:0xf bank_mask:0xf
    v_dot2c_f32_bf16_dpp v35, v13, v185 row_newbcast:14 row_mask:0xf bank_mask:0xf
    v_dot2c_f32_bf16_dpp v36, v12, v186 row_newbcast:14 row_mask:0xf bank_mask:0xf
    v_dot2c_f32_bf16_dpp v37, v13, v186 row_newbcast:14 row_mask:0xf bank_mask:0xf
    v_dot2c_f32_bf16_dpp v38, v12, v187 row_newbcast:14 row_mask:0xf bank_mask:0xf
    v_dot2c_f32_bf16_dpp v39, v13, v187 row_newbcast:14 row_mask:0xf bank_mask:0xf
    v_mov_b32 v53, v54
    s_cmp_lt_i32 s31, 0
    s_cbranch_scc0 L_ew79
    s_waitcnt vmcnt(3)
L_ew79:
    s_waitcnt vmcnt(6)
    s_cbranch_vccnz L_ev80
    s_waitcnt vmcnt(4)
L_ev80:
    buffer_load_dwordx4 v[216:219], v2, s[8:11], s16 offen offset:2048 nt
    s_memrealtime s[34:35]
    v_dot2c_f32_bf16_dpp v32, v12, v188 row_newbcast:15 row_mask:0xf bank_mask:0xf
    v_dot2c_f32_bf16_dpp v33, v13, v188 row_newbcast:15 row_mask:0xf bank_mask:0xf
    v_dot2c_f32_bf16_dpp v34, v12, v189 row_newbcast:15 row_mask:0xf bank_mask:0xf
    v_dot2c_f32_bf16_dpp v35, v13, v189 row_newbcast:15 row_mask:0xf bank_mask:0xf
    v_dot2c_f32_bf16_dpp v36, v12, v190 row_newbcast:15 row_mask:0xf bank_mask:0xf
    v_dot2c_f32_bf16_dpp v37, v13, v190 row_newbcast:15 row_mask:0xf bank_mask:0xf
    v_dot2c_f32_bf16_dpp v38, v12, v191 row_newbcast:15 row_mask:0xf bank_mask:0xf
    v_dot2c_f32_bf16_dpp v39, v13, v191 row_newbcast:15 row_mask:0xf bank_mask:0xf
    v_mov_b32 v54, v55
    s_waitcnt lgkmcnt(0)
    s_add_u32 s32, s34, s31
    s_sub_u32 s32, s32, s19
    s_cmp_gt_i32 s32, 0
    s_cselect_b64 vcc, -1, 0
    s_cselect_b32 s31, 27, 0
    s_add_u32 s19, s19, s30
    s_add_u32 s32, s32, s40
    s_cmp_lt_u32 s32, 2000
    s_cselect_b32 s31, -13, s31
    s_cmp_lt_i32 s31, 0
    s_cbranch_scc0 L_ew80
    s_waitcnt vmcnt(3)
L_ew80:
    s_waitcnt vmcnt(6)
    s_cbranch_vccnz L_ev81
    s_waitcnt vmcnt(4)
L_ev81:
    buffer_load_dwordx4 v[220:223], v2, s[8:11], s16 offen offset:3072 nt
    s_add_u32 s50, s50, 1
    s_sub_u32 s51, s50, s42
    s_cmp_le_u32 s51, 2
    s_cbranch_scc0 L_xr4
    s_cmp_eq_u32 s51, 1
    s_cbranch_scc0 L_xa4
    s_cmp_eq_u32 s43, 0
    s_cbranch_scc1 L_xr4
    v_lshrrev_b32 v14, 16, v112
    v_and_b32 v15, s26, v112
    s_nop 0
    s_branch L_xr4
L_xa4:
    v_swap_b32 v32, v116
    v_swap_b32 v33, v117
    v_swap_b32 v34, v118
    v_swap_b32 v35, v119
    v_swap_b32 v36, v120
    v_swap_b32 v37, v121
    v_swap_b32 v38, v122
    v_swap_b32 v39, v123
    s_cmp_eq_u32 s51, 0
    s_cbranch_scc0 L_xo4
    s_cmp_eq_u32 s43, 0
    s_cbranch_scc1 L_xr4
L_xw4:
    ds_read_b32 v127, v56 offset:240
    ds_read_b32 v112, v125 offset:9216
    s_waitcnt lgkmcnt(0)
    v_readfirstlane_b32 s33, v127
    v_and_b32 v14, 0xffff, v112
    v_lshlrev_b32 v15, 16, v112
    s_cmp_lt_u32 s33, 3
    s_cbranch_scc1 L_xw4
    s_branch L_xr4
L_xo4:
    v_permlane32_swap_b32 v116, v120
    v_permlane32_swap_b32 v117, v121
    v_permlane32_swap_b32 v118, v122
    v_permlane32_swap_b32 v119, v123
    v_add_f32 v116, v116, v120
    v_add_f32 v117, v117, v121
    v_add_f32 v118, v118, v122
    v_add_f32 v119, v119, v123
    s_nop 0
    v_permlane16_swap_b32 v116, v118
    v_permlane16_swap_b32 v117, v119
    v_add_f32 v116, v116, v118
    v_add_f32 v117, v117, v119
    ds_write_b64 v126, v[116:117] offset:11776
    v_mov_b32 v127, 3
    ds_write_b32 v124, v127 offset:4320
L_xr4:
    v_dot2c_f32_bf16_dpp v32, v14, v192 row_newbcast:0 row_mask:0xf bank_mask:0xf
    v_dot2c_f32_bf16_dpp v33, v15, v192 row_newbcast:0 row_mask:0xf bank_mask:0xf
    v_dot2c_f32_bf16_dpp v34, v14, v193 row_newbcast:0 row_mask:0xf bank_mask:0xf
    v_dot2c_f32_bf16_dpp v35, v15, v193 row_newbcast:0 row_mask:0xf bank_mask:0xf
    v_dot2c_f32_bf16_dpp v36, v14, v194 row_newbcast:0 row_mask:0xf bank_mask:0xf
    v_dot2c_f32_bf16_dpp v37, v15, v194 row_newbcast:0 row_mask:0xf bank_mask:0xf
    v_dot2c_f32_bf16_dpp v38, v14, v195 row_newbcast:0 row_mask:0xf bank_mask:0xf
    v_dot2c_f32_bf16_dpp v39, v15, v195 row_newbcast:0 row_mask:0xf bank_mask:0xf
    v_mov_b32 v12, v40
    v_lshlrev_b32 v13, 16, v40
    s_cmp_lt_i32 s31, 0
    s_cbranch_scc0 L_ew81
    s_waitcnt vmcnt(3)
L_ew81:
    s_waitcnt vmcnt(6)
    s_cbranch_vccnz L_ev82
    s_waitcnt vmcnt(4)
L_ev82:
    buffer_load_dwordx4 v[224:227], v3, s[8:11], s16 offen nt
    v_dot2c_f32_bf16_dpp v32, v14, v196 row_newbcast:1 row_mask:0xf bank_mask:0xf
    v_dot2c_f32_bf16_dpp v33, v15, v196 row_newbcast:1 row_mask:0xf bank_mask:0xf
    v_dot2c_f32_bf16_dpp v34, v14, v197 row_newbcast:1 row_mask:0xf bank_mask:0xf
    v_dot2c_f32_bf16_dpp v35, v15, v197 row_newbcast:1 row_mask:0xf bank_mask:0xf
    v_dot2c_f32_bf16_dpp v36, v14, v198 row_newbcast:1 row_mask:0xf bank_mask:0xf
    v_dot2c_f32_bf16_dpp v37, v15, v198 row_newbcast:1 row_mask:0xf bank_mask:0xf
    v_dot2c_f32_bf16_dpp v38, v14, v199 row_newbcast:1 row_mask:0xf bank_mask:0xf
    v_dot2c_f32_bf16_dpp v39, v15, v199 row_newbcast:1 row_mask:0xf bank_mask:0xf
    v_mov_b32 v40, v41
    s_cmp_lt_i32 s31, 0
    s_cbranch_scc0 L_ew82
    s_waitcnt vmcnt(3)
L_ew82:
    s_waitcnt vmcnt(6)
    s_cbranch_vccnz L_ev83
    s_waitcnt vmcnt(4)
L_ev83:
    buffer_load_dwordx4 v[228:231], v3, s[8:11], s16 offen offset:1024 nt
    v_dot2c_f32_bf16_dpp v32, v14, v200 row_newbcast:2 row_mask:0xf bank_mask:0xf
    v_dot2c_f32_bf16_dpp v33, v15, v200 row_newbcast:2 row_mask:0xf bank_mask:0xf
    v_dot2c_f32_bf16_dpp v34, v14, v201 row_newbcast:2 row_mask:0xf bank_mask:0xf
    v_dot2c_f32_bf16_dpp v35, v15, v201 row_newbcast:2 row_mask:0xf bank_mask:0xf
    v_dot2c_f32_bf16_dpp v36, v14, v202 row_newbcast:2 row_mask:0xf bank_mask:0xf
    v_dot2c_f32_bf16_dpp v37, v15, v202 row_newbcast:2 row_mask:0xf bank_mask:0xf
    v_dot2c_f32_bf16_dpp v38, v14, v203 row_newbcast:2 row_mask:0xf bank_mask:0xf
    v_dot2c_f32_bf16_dpp v39, v15, v203 row_newbcast:2 row_mask:0xf bank_mask:0xf
    v_mov_b32 v41, v42
    s_cmp_lt_i32 s31, 0
    s_cbranch_scc0 L_ew83
    s_waitcnt vmcnt(3)
L_ew83:
    s_waitcnt vmcnt(6)
    s_cbranch_vccnz L_ev84
    s_waitcnt vmcnt(4)
L_ev84:
    buffer_load_dwordx4 v[232:235], v3, s[8:11], s16 offen offset:2048 nt
    s_memrealtime s[34:35]
    v_dot2c_f32_bf16_dpp v32, v14, v204 row_newbcast:3 row_mask:0xf bank_mask:0xf
    v_dot2c_f32_bf16_dpp v33, v15, v204 row_newbcast:3 row_mask:0xf bank_mask:0xf
    v_dot2c_f32_bf16_dpp v34, v14, v205 row_newbcast:3 row_mask:0xf bank_mask:0xf
    v_dot2c_f32_bf16_dpp v35, v15, v205 row_newbcast:3 row_mask:0xf bank_mask:0xf
    v_dot2c_f32_bf16_dpp v36, v14, v206 row_newbcast:3 row_mask:0xf bank_mask:0xf
    v_dot2c_f32_bf16_dpp v37, v15, v206 row_newbcast:3 row_mask:0xf bank_mask:0xf
    v_dot2c_f32_bf16_dpp v38, v14, v207 row_newbcast:3 row_mask:0xf bank_mask:0xf
    v_dot2c_f32_bf16_dpp v39, v15, v207 row_newbcast:3 row_mask:0xf bank_mask:0xf
    v_mov_b32 v42, v43
    s_waitcnt lgkmcnt(0)
    s_add_u32 s32, s34, s31
    s_sub_u32 s32, s32, s19
    s_cmp_gt_i32 s32, 0
    s_cselect_b64 vcc, -1, 0
    s_cselect_b32 s31, 27, 0
    s_add_u32 s19, s19, s30
    s_add_u32 s32, s32, s40
    s_cmp_lt_u32 s32, 2000
    s_cselect_b32 s31, -13, s31
    s_cmp_lt_i32 s31, 0
    s_cbranch_scc0 L_ew84
    s_waitcnt vmcnt(3)
L_ew84:
    s_waitcnt vmcnt(6)
    s_cbranch_vccnz L_ev85
    s_waitcnt vmcnt(4)
L_ev85:
    buffer_load_dwordx4 v[236:239], v3, s[8:11], s16 offen offset:3072 nt
    v_dot2c_f32_bf16_dpp v32, v14, v208 row_newbcast:4 row_mask:0xf bank_mask:0xf
    v_dot2c_f32_bf16_dpp v33, v15, v208 row_newbcast:4 row_mask:0xf bank_mask:0xf
    v_dot2c_f32_bf16_dpp v34, v14, v209 row_newbcast:4 row_mask:0xf bank_mask:0xf
    v_dot2c_f32_bf16_dpp v35, v15, v209 row_newbcast:4 row_mask:0xf bank_mask:0xf
    v_dot2c_f32_bf16_dpp v36, v14, v210 row_newbcast:4 row_mask:0xf bank_mask:0xf
    v_dot2c_f32_bf16_dpp v37, v15, v210 row_newbcast:4 row_mask:0xf bank_mask:0xf
    v_dot2c_f32_bf16_dpp v38, v14, v211 row_newbcast:4 row_mask:0xf bank_mask:0xf
    v_dot2c_f32_bf16_dpp v39, v15, v211 row_newbcast:4 row_mask:0xf bank_mask:0xf
    v_mov_b32 v43, v44
    s_cmp_lt_i32 s31, 0
    s_cbranch_scc0 L_ew85
    s_waitcnt vmcnt(3)
L_ew85:
    s_waitcnt vmcnt(6)
    s_cbranch_vccnz L_ev86
    s_waitcnt vmcnt(4)
L_ev86:
    buffer_load_dwordx4 v[240:243], v4, s[8:11], s16 offen nt
    v_dot2c_f32_bf16_dpp v32, v14, v212 row_newbcast:5 row_mask:0xf bank_mask:0xf
    v_dot2c_f32_bf16_dpp v33, v15, v212 row_newbcast:5 row_mask:0xf bank_mask:0xf
    v_dot2c_f32_bf16_dpp v34, v14, v213 row_newbcast:5 row_mask:0xf bank_mask:0xf
    v_dot2c_f32_bf16_dpp v35, v15, v213 row_newbcast:5 row_mask:0xf bank_mask:0xf
    v_dot2c_f32_bf16_dpp v36, v14, v214 row_newbcast:5 row_mask:0xf bank_mask:0xf
    v_dot2c_f32_bf16_dpp v37, v15, v214 row_newbcast:5 row_mask:0xf bank_mask:0xf
    v_dot2c_f32_bf16_dpp v38, v14, v215 row_newbcast:5 row_mask:0xf bank_mask:0xf
    v_dot2c_f32_bf16_dpp v39, v15, v215 row_newbcast:5 row_mask:0xf bank_mask:0xf
    v_mov_b32 v44, v45
    s_cmp_lt_i32 s31, 0
    s_cbranch_scc0 L_ew86
    s_waitcnt vmcnt(3)
L_ew86:
    s_waitcnt vmcnt(6)
    s_cbranch_vccnz L_ev87
    s_waitcnt vmcnt(4)
L_ev87:
    buffer_load_dwordx4 v[244:247], v4, s[8:11], s16 offen offset:1024 nt
    v_dot2c_f32_bf16_dpp v32, v14, v216 row_newbcast:6 row_mask:0xf bank_mask:0xf
    v_dot2c_f32_bf16_dpp v33, v15, v216 row_newbcast:6 row_mask:0xf bank_mask:0xf
    v_dot2c_f32_bf16_dpp v34, v14, v217 row_newbcast:6 row_mask:0xf bank_mask:0xf
    v_dot2c_f32_bf16_dpp v35, v15, v217 row_newbcast:6 row_mask:0xf bank_mask:0xf
    v_dot2c_f32_bf16_dpp v36, v14, v218 row_newbcast:6 row_mask:0xf bank_mask:0xf
    v_dot2c_f32_bf16_dpp v37, v15, v218 row_newbcast:6 row_mask:0xf bank_mask:0xf
    v_dot2c_f32_bf16_dpp v38, v14, v219 row_newbcast:6 row_mask:0xf bank_mask:0xf
    v_dot2c_f32_bf16_dpp v39, v15, v219 row_newbcast:6 row_mask:0xf bank_mask:0xf
    v_mov_b32 v45, v46
    s_cmp_lt_i32 s31, 0
    s_cbranch_scc0 L_ew87
    s_waitcnt vmcnt(3)
L_ew87:
    s_waitcnt vmcnt(6)
    s_cbranch_vccnz L_ev88
    s_waitcnt vmcnt(4)
L_ev88:
    buffer_load_dwordx4 v[248:251], v4, s[8:11], s16 offen offset:2048 nt
    s_memrealtime s[34:35]
    v_dot2c_f32_bf16_dpp v32, v14, v220 row_newbcast:7 row_mask:0xf bank_mask:0xf
    v_dot2c_f32_bf16_dpp v33, v15, v220 row_newbcast:7 row_mask:0xf bank_mask:0xf
    v_dot2c_f32_bf16_dpp v34, v14, v221 row_newbcast:7 row_mask:0xf bank_mask:0xf
    v_dot2c_f32_bf16_dpp v35, v15, v221 row_newbcast:7 row_mask:0xf bank_mask:0xf
    v_dot2c_f32_bf16_dpp v36, v14, v222 row_newbcast:7 row_mask:0xf bank_mask:0xf
    v_dot2c_f32_bf16_dpp v37, v15, v222 row_newbcast:7 row_mask:0xf bank_mask:0xf
    v_dot2c_f32_bf16_dpp v38, v14, v223 row_newbcast:7 row_mask:0xf bank_mask:0xf
    v_dot2c_f32_bf16_dpp v39, v15, v223 row_newbcast:7 row_mask:0xf bank_mask:0xf
    v_mov_b32 v46, v47
    s_waitcnt lgkmcnt(0)
    s_sub_u32 s33, s34, 0x20000000
    s_cmp_eq_u32 s18, 15
    s_cselect_b32 s19, s33, s19
    s_add_u32 s32, s34, s31
    s_sub_u32 s32, s32, s19
    s_cmp_gt_i32 s32, 0
    s_cselect_b64 vcc, -1, 0
    s_cselect_b32 s31, 27, 0
    s_add_u32 s19, s19, s30
    s_add_u32 s32, s32, s40
    s_cmp_lt_u32 s32, 2000
    s_cselect_b32 s31, -13, s31
    s_cmp_lt_i32 s31, 0
    s_cbranch_scc0 L_ew88
    s_waitcnt vmcnt(3)
L_ew88:
    s_waitcnt vmcnt(6)
    s_cbranch_vccnz L_ev89
    s_waitcnt vmcnt(4)
L_ev89:
    buffer_load_dwordx4 v[252:255], v4, s[8:11], s16 offen offset:3072 nt
    s_add_u32 s14, s14, 0x20000
    s_and_b32 s16, s14, 0xe0000
    s_lshr_b32 s27, s14, 6
    s_and_b32 s27, s27, 0x4000
    s_or_b32 s16, s16, s27
    s_xor_b32 s16, s16, s15
    s_add_u32 s41, s41, 1
    s_sub_u32 s27, s41, s42
    s_cmp_lt_u32 s27, 2
    s_cselect_b32 s27, s43, 0
    s_xor_b32 s16, s16, s27
    s_cmp_eq_u32 s18, 15
    s_cselect_b32 s10, 0, s10
    v_dot2c_f32_bf16_dpp v32, v14, v224 row_newbcast:8 row_mask:0xf bank_mask:0xf
    v_dot2c_f32_bf16_dpp v33, v15, v224 row_newbcast:8 row_mask:0xf bank_mask:0xf
    v_dot2c_f32_bf16_dpp v34, v14, v225 row_newbcast:8 row_mask:0xf bank_mask:0xf
    v_dot2c_f32_bf16_dpp v35, v15, v225 row_newbcast:8 row_mask:0xf bank_mask:0xf
    v_dot2c_f32_bf16_dpp v36, v14, v226 row_newbcast:8 row_mask:0xf bank_mask:0xf
    v_dot2c_f32_bf16_dpp v37, v15, v226 row_newbcast:8 row_mask:0xf bank_mask:0xf
    v_dot2c_f32_bf16_dpp v38, v14, v227 row_newbcast:8 row_mask:0xf bank_mask:0xf
    v_dot2c_f32_bf16_dpp v39, v15, v227 row_newbcast:8 row_mask:0xf bank_mask:0xf
    v_mov_b32 v47, v48
    s_cmp_lt_i32 s31, 0
    s_cbranch_scc0 L_ew89
    s_waitcnt vmcnt(3)
L_ew89:
    s_waitcnt vmcnt(6)
    s_cbranch_vccnz L_ev90
    s_waitcnt vmcnt(4)
L_ev90:
    buffer_load_dwordx4 v[128:131], v1, s[8:11], s16 offen nt
    v_dot2c_f32_bf16_dpp v32, v14, v228 row_newbcast:9 row_mask:0xf bank_mask:0xf
    v_dot2c_f32_bf16_dpp v33, v15, v228 row_newbcast:9 row_mask:0xf bank_mask:0xf
    v_dot2c_f32_bf16_dpp v34, v14, v229 row_newbcast:9 row_mask:0xf bank_mask:0xf
    v_dot2c_f32_bf16_dpp v35, v15, v229 row_newbcast:9 row_mask:0xf bank_mask:0xf
    v_dot2c_f32_bf16_dpp v36, v14, v230 row_newbcast:9 row_mask:0xf bank_mask:0xf
    v_dot2c_f32_bf16_dpp v37, v15, v230 row_newbcast:9 row_mask:0xf bank_mask:0xf
    v_dot2c_f32_bf16_dpp v38, v14, v231 row_newbcast:9 row_mask:0xf bank_mask:0xf
    v_dot2c_f32_bf16_dpp v39, v15, v231 row_newbcast:9 row_mask:0xf bank_mask:0xf
    v_mov_b32 v48, v49
    s_cmp_lt_i32 s31, 0
    s_cbranch_scc0 L_ew90
    s_waitcnt vmcnt(3)
L_ew90:
    s_waitcnt vmcnt(6)
    s_cbranch_vccnz L_ev91
    s_waitcnt vmcnt(4)
L_ev91:
    buffer_load_dwordx4 v[132:135], v1, s[8:11], s16 offen offset:1024 nt
    v_dot2c_f32_bf16_dpp v32, v14, v232 row_newbcast:10 row_mask:0xf bank_mask:0xf
    v_dot2c_f32_bf16_dpp v33, v15, v232 row_newbcast:10 row_mask:0xf bank_mask:0xf
    v_dot2c_f32_bf16_dpp v34, v14, v233 row_newbcast:10 row_mask:0xf bank_mask:0xf
    v_dot2c_f32_bf16_dpp v35, v15, v233 row_newbcast:10 row_mask:0xf bank_mask:0xf
    v_dot2c_f32_bf16_dpp v36, v14, v234 row_newbcast:10 row_mask:0xf bank_mask:0xf
    v_dot2c_f32_bf16_dpp v37, v15, v234 row_newbcast:10 row_mask:0xf bank_mask:0xf
    v_dot2c_f32_bf16_dpp v38, v14, v235 row_newbcast:10 row_mask:0xf bank_mask:0xf
    v_dot2c_f32_bf16_dpp v39, v15, v235 row_newbcast:10 row_mask:0xf bank_mask:0xf
    v_mov_b32 v49, v50
    s_cmp_lt_i32 s31, 0
    s_cbranch_scc0 L_ew91
    s_waitcnt vmcnt(3)
L_ew91:
    s_waitcnt vmcnt(6)
    s_cbranch_vccnz L_ev92
    s_waitcnt vmcnt(4)
L_ev92:
    buffer_load_dwordx4 v[136:139], v1, s[8:11], s16 offen offset:2048 nt
    s_memrealtime s[34:35]
    v_dot2c_f32_bf16_dpp v32, v14, v236 row_newbcast:11 row_mask:0xf bank_mask:0xf
    v_dot2c_f32_bf16_dpp v33, v15, v236 row_newbcast:11 row_mask:0xf bank_mask:0xf
    v_dot2c_f32_bf16_dpp v34, v14, v237 row_newbcast:11 row_mask:0xf bank_mask:0xf
    v_dot2c_f32_bf16_dpp v35, v15, v237 row_newbcast:11 row_mask:0xf bank_mask:0xf
    v_dot2c_f32_bf16_dpp v36, v14, v238 row_newbcast:11 row_mask:0xf bank_mask:0xf
    v_dot2c_f32_bf16_dpp v37, v15, v238 row_newbcast:11 row_mask:0xf bank_mask:0xf
    v_dot2c_f32_bf16_dpp v38, v14, v239 row_newbcast:11 row_mask:0xf bank_mask:0xf
    v_dot2c_f32_bf16_dpp v39, v15, v239 row_newbcast:11 row_mask:0xf bank_mask:0xf
    v_mov_b32 v50, v51
    s_waitcnt lgkmcnt(0)
    s_add_u32 s32, s34, s31
    s_sub_u32 s32, s32, s19
    s_cmp_gt_i32 s32, 0
    s_cselect_b64 vcc, -1, 0
    s_cselect_b32 s31, 27, 0
    s_add_u32 s19, s19, s30
    s_add_u32 s32, s32, s40
    s_cmp_lt_u32 s32, 2000
    s_cselect_b32 s31, -13, s31
    s_cmp_lt_i32 s31, 0
    s_cbranch_scc0 L_ew92
    s_waitcnt vmcnt(3)
L_ew92:
    s_waitcnt vmcnt(6)
    s_cbranch_vccnz L_ev93
    s_waitcnt vmcnt(4)
L_ev93:
    buffer_load_dwordx4 v[140:143], v1, s[8:11], s16 offen offset:3072 nt
    v_dot2c_f32_bf16_dpp v32, v14, v240 row_newbcast:12 row_mask:0xf bank_mask:0xf
    v_dot2c_f32_bf16_dpp v33, v15, v240 row_newbcast:12 row_mask:0xf bank_mask:0xf
    v_dot2c_f32_bf16_dpp v34, v14, v241 row_newbcast:12 row_mask:0xf bank_mask:0xf
    v_dot2c_f32_bf16_dpp v35, v15, v241 row_newbcast:12 row_mask:0xf bank_mask:0xf
    v_dot2c_f32_bf16_dpp v36, v14, v242 row_newbcast:12 row_mask:0xf bank_mask:0xf
    v_dot2c_f32_bf16_dpp v37, v15, v242 row_newbcast:12 row_mask:0xf bank_mask:0xf
    v_dot2c_f32_bf16_dpp v38, v14, v243 row_newbcast:12 row_mask:0xf bank_mask:0xf
    v_dot2c_f32_bf16_dpp v39, v15, v243 row_newbcast:12 row_mask:0xf bank_mask:0xf
    v_mov_b32 v51, v52
    s_cmp_lt_i32 s31, 0
    s_cbranch_scc0 L_ew93
    s_waitcnt vmcnt(3)
L_ew93:
    s_waitcnt vmcnt(6)
    s_cbranch_vccnz L_ev94
    s_waitcnt vmcnt(4)
L_ev94:
    buffer_load_dwordx4 v[144:147], v2, s[8:11], s16 offen nt
    v_dot2c_f32_bf16_dpp v32, v14, v244 row_newbcast:13 row_mask:0xf bank_mask:0xf
    v_dot2c_f32_bf16_dpp v33, v15, v244 row_newbcast:13 row_mask:0xf bank_mask:0xf
    v_dot2c_f32_bf16_dpp v34, v14, v245 row_newbcast:13 row_mask:0xf bank_mask:0xf
    v_dot2c_f32_bf16_dpp v35, v15, v245 row_newbcast:13 row_mask:0xf bank_mask:0xf
    v_dot2c_f32_bf16_dpp v36, v14, v246 row_newbcast:13 row_mask:0xf bank_mask:0xf
    v_dot2c_f32_bf16_dpp v37, v15, v246 row_newbcast:13 row_mask:0xf bank_mask:0xf
    v_dot2c_f32_bf16_dpp v38, v14, v247 row_newbcast:13 row_mask:0xf bank_mask:0xf
    v_dot2c_f32_bf16_dpp v39, v15, v247 row_newbcast:13 row_mask:0xf bank_mask:0xf
    v_mov_b32 v52, v53
    s_cmp_lt_i32 s31, 0
    s_cbranch_scc0 L_ew94
    s_waitcnt vmcnt(3)
L_ew94:
    s_waitcnt vmcnt(6)
    s_cbranch_vccnz L_ev95
    s_waitcnt vmcnt(4)
L_ev95:
    buffer_load_dwordx4 v[148:151], v2, s[8:11], s16 offen offset:1024 nt
    v_dot2c_f32_bf16_dpp v32, v14, v248 row_newbcast:14 row_mask:0xf bank_mask:0xf
    v_dot2c_f32_bf16_dpp v33, v15, v248 row_newbcast:14 row_mask:0xf bank_mask:0xf
    v_dot2c_f32_bf16_dpp v34, v14, v249 row_newbcast:14 row_mask:0xf bank_mask:0xf
    v_dot2c_f32_bf16_dpp v35, v15, v249 row_newbcast:14 row_mask:0xf bank_mask:0xf
    v_dot2c_f32_bf16_dpp v36, v14, v250 row_newbcast:14 row_mask:0xf bank_mask:0xf
    v_dot2c_f32_bf16_dpp v37, v15, v250 row_newbcast:14 row_mask:0xf bank_mask:0xf
    v_dot2c_f32_bf16_dpp v38, v14, v251 row_newbcast:14 row_mask:0xf bank_mask:0xf
    v_dot2c_f32_bf16_dpp v39, v15, v251 row_newbcast:14 row_mask:0xf bank_mask:0xf
    v_mov_b32 v53, v54
    s_cmp_lt_i32 s31, 0
    s_cbranch_scc0 L_ew95
    s_waitcnt vmcnt(3)
L_ew95:
    s_waitcnt vmcnt(6)
    s_cbranch_vccnz L_ev96
    s_waitcnt vmcnt(4)
L_ev96:
    buffer_load_dwordx4 v[152:155], v2, s[8:11], s16 offen offset:2048 nt
    s_memrealtime s[34:35]
    v_dot2c_f32_bf16_dpp v32, v14, v252 row_newbcast:15 row_mask:0xf bank_mask:0xf
    v_dot2c_f32_bf16_dpp v33, v15, v252 row_newbcast:15 row_mask:0xf bank_mask:0xf
    v_dot2c_f32_bf16_dpp v34, v14, v253 row_newbcast:15 row_mask:0xf bank_mask:0xf
    v_dot2c_f32_bf16_dpp v35, v15, v253 row_newbcast:15 row_mask:0xf bank_mask:0xf
    v_dot2c_f32_bf16_dpp v36, v14, v254 row_newbcast:15 row_mask:0xf bank_mask:0xf
    v_dot2c_f32_bf16_dpp v37, v15, v254 row_newbcast:15 row_mask:0xf bank_mask:0xf
    v_dot2c_f32_bf16_dpp v38, v14, v255 row_newbcast:15 row_mask:0xf bank_mask:0xf
    v_dot2c_f32_bf16_dpp v39, v15, v255 row_newbcast:15 row_mask:0xf bank_mask:0xf
    v_mov_b32 v54, v55
    s_add_u32 s18, s18, 1
    s_cmp_lt_u32 s18, 16
    s_cbranch_scc1 L_vloop
    v_permlane32_swap_b32 v32, v36
    v_permlane32_swap_b32 v33, v37
    v_permlane32_swap_b32 v34, v38
    v_permlane32_swap_b32 v35, v39
    v_add_f32 v32, v32, v36
    v_add_f32 v33, v33, v37
    v_add_f32 v34, v34, v38
    v_add_f32 v35, v35, v39
    s_nop 0
    v_permlane16_swap_b32 v32, v34
    v_permlane16_swap_b32 v33, v35
    v_add_f32 v32, v32, v34
    v_add_f32 v33, v33, v35
    ds_write_b64 v7, v[32:33]
    s_waitcnt lgkmcnt(0)
    s_barrier
    s_endpgm
.p2align 6
L_aux:
    s_load_dwordx2 s[8:9], s[0:1], 0
    s_load_dwordx4 s[12:15], s[0:1], 24
    s_load_dwordx8 s[16:23], s[0:1], 48
    s_load_dwordx4 s[24:27], s[0:1], 80
    s_sub_u32 s3, s3, 4
    s_lshr_b32 s30, s2, 5
    s_and_b32 s31, s2, 31
    v_lshrrev_b32 v2, 4, v5
    v_and_b32 v3, 15, v5
    v_mov_b32 v56, 4096
    v_lshl_add_u32 v16, v5, 2, v56
    v_mov_b32 v17, 0
    ds_write_b32 v16, v17
    s_lshl_b32 s4, s30, 10
    v_lshl_add_u32 v6, v5, 4, s4
    s_lshl_b32 s5, s3, 8
    s_add_u32 s5, s5, s4
    s_lshl_b32 s6, s30, 1
    v_add_u32 v7, s6, v3
    v_and_b32 v7, 15, v7
    v_lshl_add_u32 v7, v2, 4, v7
    v_lshl_add_u32 v7, v7, 2, s5
    s_lshl_b32 s5, s31, 5
    s_add_u32 s5, s5, s4
    s_lshl_b32 s6, s3, 3
    s_add_u32 s6, s6, s5
    v_mov_b32 v4, s6
    s_lshl_b32 s6, s3, 20
    s_lshl_b32 s7, s31, 8
    s_add_u32 s6, s6, s7
    v_lshlrev_b32 v1, 18, v2
    v_lshl_add_u32 v1, v3, 4, v1
    v_add_u32 v1, s6, v1
    s_mov_b32 s10, 8192
    s_mov_b32 s11, 0x20000
    s_mov_b32 s34, 0x400000
    s_mov_b32 s35, 0x20000
    s_mov_b32 s46, 0x100000
    s_mov_b32 s47, 0x20000
    s_lshl_b32 s6, s2, 11
    v_lshl_add_u32 v39, v5, 4, s6
    s_lshl_b32 s58, s30, 2
    s_add_u32 s58, s58, s3
    s_lshl_b32 s7, s30, 15
    s_waitcnt lgkmcnt(0)
    s_mov_b32 s32, s12
    s_mov_b32 s33, s13
    s_add_u32 s44, s28, 0
    s_addc_u32 s45, s29, 0
    s_add_u32 s6, s30, 8
    s_cmp_lg_u32 s31, s6
    s_cbranch_scc1 L_noclear
    s_lshl_b32 s6, s58, 14
    v_lshl_add_u32 v46, v5, 4, s6
    v_mov_b32 v40, -1
    v_mov_b32 v41, -1
    v_mov_b32 v42, -1
    v_mov_b32 v43, -1
    s_mov_b32 s6, 0
    buffer_store_dwordx4 v[40:43], v46, s[44:47], s6 offen sc1
    buffer_store_dwordx4 v[40:43], v46, s[44:47], s6 offen offset:1024 sc1
    buffer_store_dwordx4 v[40:43], v46, s[44:47], s6 offen offset:2048 sc1
    buffer_store_dwordx4 v[40:43], v46, s[44:47], s6 offen offset:3072 sc1
    s_mov_b32 s6, 4096
    buffer_store_dwordx4 v[40:43], v46, s[44:47], s6 offen sc1
    buffer_store_dwordx4 v[40:43], v46, s[44:47], s6 offen offset:1024 sc1
    buffer_store_dwordx4 v[40:43], v46, s[44:47], s6 offen offset:2048 sc1
    buffer_store_dwordx4 v[40:43], v46, s[44:47], s6 offen offset:3072 sc1
    s_mov_b32 s6, 8192
    buffer_store_dwordx4 v[40:43], v46, s[44:47], s6 offen sc1
    buffer_store_dwordx4 v[40:43], v46, s[44:47], s6 offen offset:1024 sc1
    buffer_store_dwordx4 v[40:43], v46, s[44:47], s6 offen offset:2048 sc1
    buffer_store_dwordx4 v[40:43], v46, s[44:47], s6 offen offset:3072 sc1
    s_mov_b32 s6, 12288
    buffer_store_dwordx4 v[40:43], v46, s[44:47], s6 offen sc1
    buffer_store_dwordx4 v[40:43], v46, s[44:47], s6 offen offset:1024 sc1
    buffer_store_dwordx4 v[40:43], v46, s[44:47], s6 offen offset:2048 sc1
    buffer_store_dwordx4 v[40:43], v46, s[44:47], s6 offen offset:3072 sc1
    s_mul_i32 s6, s58, 2048
    s_add_u32 s6, s6, 0x80000
    v_lshlrev_b32 v46, 4, v5
    buffer_store_dwordx4 v[40:43], v46, s[44:47], s6 offen offset:0 sc1
    buffer_store_dwordx4 v[40:43], v46, s[44:47], s6 offen offset:1024 sc1
L_noclear:
    s_lshl_b32 s6, s2, 2
    s_or_b32 s6, s6, s3
    s_mul_i32 s59, s30, 132
    s_add_u32 s59, s59, 65
    s_cmp_eq_u32 s6, s59
    s_cselect_b32 s90, 1, 0
    s_cbranch_scc0 L_nokc
    s_lshl_b32 s6, s30, 13
    s_add_u32 s6, s6, 0xa0000
    v_lshlrev_b32 v46, 4, v5
    v_mov_b32 v40, -1
    v_mov_b32 v41, -1
    v_mov_b32 v42, -1
    v_mov_b32 v43, -1
    buffer_store_dwordx4 v[40:43], v46, s[44:47], s6 offen offset:0 sc1
    buffer_store_dwordx4 v[40:43], v46, s[44:47], s6 offen offset:1024 sc1
    buffer_store_dwordx4 v[40:43], v46, s[44:47], s6 offen offset:2048 sc1
    buffer_store_dwordx4 v[40:43], v46, s[44:47], s6 offen offset:3072 sc1
    s_add_u32 s6, s6, 4096
    buffer_store_dwordx4 v[40:43], v46, s[44:47], s6 offen offset:0 sc1
    buffer_store_dwordx4 v[40:43], v46, s[44:47], s6 offen offset:1024 sc1
    buffer_store_dwordx4 v[40:43], v46, s[44:47], s6 offen offset:2048 sc1
    buffer_store_dwordx4 v[40:43], v46, s[44:47], s6 offen offset:3072 sc1
L_nokc:
    s_cmp_lg_u32 s3, 3
    s_cbranch_scc1 L_nocpf
    s_getpc_b64 s[88:89]
L_pc:
    s_sub_u32 s88, s88, L_pc-parallel_sum__mha_block_cached__mixer_token_mlp__decode_kernel
    s_subb_u32 s89, s89, 0
    s_lshr_b32 s6, s2, 3
    s_lshl_b32 s6, s6, 10
    v_lshl_add_u32 v16, v5, 4, s6
    v_min_u32 v16, L_last-parallel_sum__mha_block_cached__mixer_token_mlp__decode_kernel-16, v16
    v_mov_b32 v17, s89
    v_add_co_u32 v16, vcc, s88, v16
    s_nop 1
    v_addc_co_u32 v17, vcc, 0, v17, vcc
    global_load_dwordx4 v[20:23], v[16:17], off
L_nocpf:
    buffer_load_dwordx4 v[8:11], v6, s[8:11], 0 offen
    buffer_load_dword v12, v7, s[8:11], 0 offen
    buffer_load_dwordx2 v[14:15], v4, s[8:11], 0 offen
    buffer_load_dwordx4 v[128:131], v1, s[32:35], s7 offen
    s_add_u32 s7, s7, 8192
    s_and_b32 s7, s7, 262143
    buffer_load_dwordx4 v[132:135], v1, s[32:35], s7 offen
    s_add_u32 s7, s7, 8192
    s_and_b32 s7, s7, 262143
    buffer_load_dwordx4 v[136:139], v1, s[32:35], s7 offen
    s_add_u32 s7, s7, 8192
    s_and_b32 s7, s7, 262143
    buffer_load_dwordx4 v[140:143], v1, s[32:35], s7 offen
    s_add_u32 s7, s7, 8192
    s_and_b32 s7, s7, 262143
    s_barrier
    s_lshl_b32 s6, s31, 17
    s_add_u32 s92, s14, s6
    s_addc_u32 s93, s15, 0
    s_mov_b32 s94, 0x20000
    s_mov_b32 s95, 0x20000
    s_lshl_b32 s6, s3, 8
    v_lshlrev_b32 v0, 15, v2
    v_lshl_add_u32 v0, v3, 4, v0
    v_add_u32 v0, s6, v0
    s_lshl_b32 s91, s30, 12
    s_mov_b32 s36, 0xffff0000
    s_mov_b32 s37, 0x3b000000
    s_mov_b32 s38, 0x3727c5ac
    s_mov_b32 s39, 0x05040100
    s_mov_b32 s40, 0x07060302
    s_add_u32 s6, s30, 12
    s_lshl_b32 s6, s6, 17
    s_and_b32 s41, s6, 0xe0000
    s_lshr_b32 s6, s6, 6
    s_and_b32 s6, s6, 0x4000
    s_or_b32 s41, s41, s6
    s_and_b32 s6, s2, 28
    s_lshl_b32 s6, s6, 15
    s_xor_b32 s41, s41, s6
    s_and_b32 s6, s2, 1
    s_lshl_b32 s6, s6, 14
    s_xor_b32 s41, s41, s6
    s_lshl_b32 s6, s2, 20
    s_add_u32 s42, s52, s6
    s_addc_u32 s43, s53, 0
    s_mov_b32 s59, 0
    s_cmp_lg_u32 s90, 0
    s_cselect_b64 vcc, -1, 0
    s_cbranch_vccz L_npw
    s_load_dword s84, s[42:43], 0x80
L_npw:
    s_waitcnt vmcnt(4)
    s_cbranch_vccnz L_lo4
    s_waitcnt vmcnt(2)
L_lo4:
    buffer_load_dwordx4 v[144:147], v1, s[32:35], s7 offen
    s_add_u32 s7, s7, 8192
    s_and_b32 s7, s7, 262143
    s_waitcnt vmcnt(5)
    v_lshlrev_b32 v16, 16, v8
    v_and_b32 v17, s36, v8
    v_lshlrev_b32 v18, 16, v9
    v_and_b32 v19, s36, v9
    v_lshlrev_b32 v20, 16, v10
    v_and_b32 v21, s36, v10
    v_lshlrev_b32 v22, 16, v11
    v_and_b32 v23, s36, v11
    v_add_f32 v24, v16, v17
    v_add_f32 v25, v18, v19
    v_add_f32 v26, v20, v21
    v_add_f32 v27, v22, v23
    v_add_f32 v24, v24, v25
    v_add_f32 v26, v26, v27
    v_add_f32 v24, v24, v26
    s_nop 1
    v_add_f32_dpp v24, v24, v24 row_ror:8 row_mask:0xf bank_mask:0xf
    s_nop 1
    v_add_f32_dpp v24, v24, v24 row_ror:4 row_mask:0xf bank_mask:0xf
    s_nop 1
    v_add_f32_dpp v24, v24, v24 row_ror:2 row_mask:0xf bank_mask:0xf
    s_nop 1
    v_add_f32_dpp v24, v24, v24 row_ror:1 row_mask:0xf bank_mask:0xf
    v_mov_b32 v25, v24
    s_nop 1
    v_permlane16_swap_b32 v24, v25
    v_add_f32 v24, v24, v25
    v_mov_b32 v25, v24
    s_nop 1
    v_permlane32_swap_b32 v24, v25
    v_add_f32 v24, v24, v25
    v_mul_f32 v24, s37, v24
    v_sub_f32 v26, v16, v24
    v_sub_f32 v27, v17, v24
    v_sub_f32 v28, v18, v24
    v_sub_f32 v29, v19, v24
    v_sub_f32 v30, v20, v24
    v_sub_f32 v31, v21, v24
    v_sub_f32 v32, v22, v24
    v_sub_f32 v33, v23, v24
    v_mul_f32 v25, v26, v26
    v_fmac_f32 v25, v27, v27
    v_fmac_f32 v25, v28, v28
    v_fmac_f32 v25, v29, v29
    v_fmac_f32 v25, v30, v30
    v_fmac_f32 v25, v31, v31
    v_fmac_f32 v25, v32, v32
    v_fmac_f32 v25, v33, v33
    s_nop 1
    v_add_f32_dpp v25, v25, v25 row_ror:8 row_mask:0xf bank_mask:0xf
    s_nop 1
    v_add_f32_dpp v25, v25, v25 row_ror:4 row_mask:0xf bank_mask:0xf
    s_nop 1
    v_add_f32_dpp v25, v25, v25 row_ror:2 row_mask:0xf bank_mask:0xf
    s_nop 1
    v_add_f32_dpp v25, v25, v25 row_ror:1 row_mask:0xf bank_mask:0xf
    v_mov_b32 v26, v25
    s_nop 1
    v_permlane16_swap_b32 v25, v26
    v_add_f32 v25, v25, v26
    v_mov_b32 v26, v25
    s_nop 1
    v_permlane32_swap_b32 v25, v26
    v_add_f32 v25, v25, v26
    v_mul_f32 v25, s37, v25
    v_cvt_pk_bf16_f32 v34, v24, v24
    v_and_b32 v34, s36, v34
    v_cvt_pk_bf16_f32 v25, v25, v25
    v_and_b32 v25, s36, v25
    v_add_f32 v25, s38, v25
    v_cvt_pk_bf16_f32 v25, v25, v25
    v_and_b32 v25, s36, v25
    v_sqrt_f32 v25, v25
    s_nop 0
    v_cvt_pk_bf16_f32 v25, v25, v25
    v_and_b32 v25, s36, v25
    v_rcp_f32 v35, v25
    s_cbranch_vccz L_np4
    s_call_b64 s[56:57], L_lat
L_np4:
    s_waitcnt vmcnt(4)
    s_cbranch_vccnz L_lo5
    s_waitcnt vmcnt(2)
L_lo5:
    buffer_load_dwordx4 v[148:151], v1, s[32:35], s7 offen
    s_add_u32 s7, s7, 8192
    s_and_b32 s7, s7, 262143
    v_lshlrev_b32 v36, 16, v12
    v_and_b32 v37, s36, v12
    v_sub_f32 v36, v36, v34
    v_sub_f32 v37, v37, v34
    v_cvt_pk_bf16_f32 v36, v36, v37
    v_and_b32 v37, s36, v36
    v_lshlrev_b32 v36, 16, v36
    v_mul_f32 v36, v36, v35
    v_mul_f32 v37, v37, v35
    v_cvt_pk_bf16_f32 v36, v36, v37
    v_mov_b32 v40, 0
    v_mov_b32 v41, 0
    v_mov_b32 v42, 0
    v_mov_b32 v43, 0
    v_mov_b32 v44, 0
    v_mov_b32 v45, 0
    v_mov_b32 v46, 0
    v_mov_b32 v47, 0
    v_lshlrev_b32 v13, 5, v3
    v_lshl_add_u32 v13, v2, 3, v13
    s_lshl_b32 s6, s3, 9
    v_add_u32 v38, s6, v13
    s_waitcnt vmcnt(4)
    s_cbranch_vccnz L_lo6
    s_waitcnt vmcnt(2)
L_lo6:
    buffer_load_dwordx4 v[152:155], v1, s[32:35], s7 offen
    s_add_u32 s7, s7, 8192
    s_and_b32 s7, s7, 262143
    v_perm_b32 v64, v132, v128, s39
    v_perm_b32 v65, v132, v128, s40
    v_perm_b32 v66, v133, v129, s39
    v_perm_b32 v67, v133, v129, s40
    v_perm_b32 v68, v134, v130, s39
    v_perm_b32 v69, v134, v130, s40
    v_perm_b32 v70, v135, v131, s39
    v_perm_b32 v71, v135, v131, s40
    v_dot2c_f32_bf16_dpp v40, v36, v64 row_newbcast:0 row_mask:0xf bank_mask:0xf
    v_dot2c_f32_bf16_dpp v41, v36, v65 row_newbcast:0 row_mask:0xf bank_mask:0xf
    v_dot2c_f32_bf16_dpp v42, v36, v66 row_newbcast:0 row_mask:0xf bank_mask:0xf
    v_dot2c_f32_bf16_dpp v43, v36, v67 row_newbcast:0 row_mask:0xf bank_mask:0xf
    v_dot2c_f32_bf16_dpp v44, v36, v68 row_newbcast:0 row_mask:0xf bank_mask:0xf
    v_dot2c_f32_bf16_dpp v45, v36, v69 row_newbcast:0 row_mask:0xf bank_mask:0xf
    v_dot2c_f32_bf16_dpp v46, v36, v70 row_newbcast:0 row_mask:0xf bank_mask:0xf
    v_dot2c_f32_bf16_dpp v47, v36, v71 row_newbcast:0 row_mask:0xf bank_mask:0xf
    s_cbranch_vccz L_np6
    s_call_b64 s[56:57], L_lat
L_np6:
    s_waitcnt vmcnt(4)
    s_cbranch_vccnz L_lo7
    s_waitcnt vmcnt(2)
L_lo7:
    buffer_load_dwordx4 v[156:159], v1, s[32:35], s7 offen
    s_add_u32 s7, s7, 8192
    s_and_b32 s7, s7, 262143
    s_waitcnt vmcnt(4)
    s_cbranch_vccnz L_lo8
    s_waitcnt vmcnt(2)
L_lo8:
    buffer_load_dwordx4 v[160:163], v1, s[32:35], s7 offen
    s_add_u32 s7, s7, 8192
    s_and_b32 s7, s7, 262143
    v_perm_b32 v72, v140, v136, s39
    v_perm_b32 v73, v140, v136, s40
    v_perm_b32 v74, v141, v137, s39
    v_perm_b32 v75, v141, v137, s40
    v_perm_b32 v76, v142, v138, s39
    v_perm_b32 v77, v142, v138, s40
    v_perm_b32 v78, v143, v139, s39
    v_perm_b32 v79, v143, v139, s40
    v_dot2c_f32_bf16_dpp v40, v36, v72 row_newbcast:1 row_mask:0xf bank_mask:0xf
    v_dot2c_f32_bf16_dpp v41, v36, v73 row_newbcast:1 row_mask:0xf bank_mask:0xf
    v_dot2c_f32_bf16_dpp v42, v36, v74 row_newbcast:1 row_mask:0xf bank_mask:0xf
    v_dot2c_f32_bf16_dpp v43, v36, v75 row_newbcast:1 row_mask:0xf bank_mask:0xf
    v_dot2c_f32_bf16_dpp v44, v36, v76 row_newbcast:1 row_mask:0xf bank_mask:0xf
    v_dot2c_f32_bf16_dpp v45, v36, v77 row_newbcast:1 row_mask:0xf bank_mask:0xf
    v_dot2c_f32_bf16_dpp v46, v36, v78 row_newbcast:1 row_mask:0xf bank_mask:0xf
    v_dot2c_f32_bf16_dpp v47, v36, v79 row_newbcast:1 row_mask:0xf bank_mask:0xf
    s_cbranch_vccz L_np8
    s_call_b64 s[56:57], L_lat
L_np8:
    s_waitcnt vmcnt(4)
    s_cbranch_vccnz L_lo9
    s_waitcnt vmcnt(2)
L_lo9:
    buffer_load_dwordx4 v[164:167], v1, s[32:35], s7 offen
    s_add_u32 s7, s7, 8192
    s_and_b32 s7, s7, 262143
    s_waitcnt vmcnt(4)
    s_cbranch_vccnz L_lo10
    s_waitcnt vmcnt(2)
L_lo10:
    buffer_load_dwordx4 v[168:171], v1, s[32:35], s7 offen
    s_add_u32 s7, s7, 8192
    s_and_b32 s7, s7, 262143
    v_perm_b32 v64, v148, v144, s39
    v_perm_b32 v65, v148, v144, s40
    v_perm_b32 v66, v149, v145, s39
    v_perm_b32 v67, v149, v145, s40
    v_perm_b32 v68, v150, v146, s39
    v_perm_b32 v69, v150, v146, s40
    v_perm_b32 v70, v151, v147, s39
    v_perm_b32 v71, v151, v147, s40
    v_dot2c_f32_bf16_dpp v40, v36, v64 row_newbcast:2 row_mask:0xf bank_mask:0xf
    v_dot2c_f32_bf16_dpp v41, v36, v65 row_newbcast:2 row_mask:0xf bank_mask:0xf
    v_dot2c_f32_bf16_dpp v42, v36, v66 row_newbcast:2 row_mask:0xf bank_mask:0xf
    v_dot2c_f32_bf16_dpp v43, v36, v67 row_newbcast:2 row_mask:0xf bank_mask:0xf
    v_dot2c_f32_bf16_dpp v44, v36, v68 row_newbcast:2 row_mask:0xf bank_mask:0xf
    v_dot2c_f32_bf16_dpp v45, v36, v69 row_newbcast:2 row_mask:0xf bank_mask:0xf
    v_dot2c_f32_bf16_dpp v46, v36, v70 row_newbcast:2 row_mask:0xf bank_mask:0xf
    v_dot2c_f32_bf16_dpp v47, v36, v71 row_newbcast:2 row_mask:0xf bank_mask:0xf
    s_cbranch_vccz L_np10
    s_call_b64 s[56:57], L_lat
L_np10:
    s_waitcnt vmcnt(4)
    s_cbranch_vccnz L_lo11
    s_waitcnt vmcnt(2)
L_lo11:
    buffer_load_dwordx4 v[172:175], v1, s[32:35], s7 offen
    s_add_u32 s7, s7, 8192
    s_and_b32 s7, s7, 262143
    s_waitcnt vmcnt(4)
    s_cbranch_vccnz L_lo12
    s_waitcnt vmcnt(2)
L_lo12:
    buffer_load_dwordx4 v[176:179], v1, s[32:35], s7 offen
    s_add_u32 s7, s7, 8192
    s_and_b32 s7, s7, 262143
    v_perm_b32 v72, v156, v152, s39
    v_perm_b32 v73, v156, v152, s40
    v_perm_b32 v74, v157, v153, s39
    v_perm_b32 v75, v157, v153, s40
    v_perm_b32 v76, v158, v154, s39
    v_perm_b32 v77, v158, v154, s40
    v_perm_b32 v78, v159, v155, s39
    v_perm_b32 v79, v159, v155, s40
    v_dot2c_f32_bf16_dpp v40, v36, v72 row_newbcast:3 row_mask:0xf bank_mask:0xf
    v_dot2c_f32_bf16_dpp v41, v36, v73 row_newbcast:3 row_mask:0xf bank_mask:0xf
    v_dot2c_f32_bf16_dpp v42, v36, v74 row_newbcast:3 row_mask:0xf bank_mask:0xf
    v_dot2c_f32_bf16_dpp v43, v36, v75 row_newbcast:3 row_mask:0xf bank_mask:0xf
    v_dot2c_f32_bf16_dpp v44, v36, v76 row_newbcast:3 row_mask:0xf bank_mask:0xf
    v_dot2c_f32_bf16_dpp v45, v36, v77 row_newbcast:3 row_mask:0xf bank_mask:0xf
    v_dot2c_f32_bf16_dpp v46, v36, v78 row_newbcast:3 row_mask:0xf bank_mask:0xf
    v_dot2c_f32_bf16_dpp v47, v36, v79 row_newbcast:3 row_mask:0xf bank_mask:0xf
    s_cbranch_vccz L_np12
    s_call_b64 s[56:57], L_lat
L_np12:
    s_waitcnt vmcnt(4)
    s_cbranch_vccnz L_lo13
    s_waitcnt vmcnt(2)
L_lo13:
    buffer_load_dwordx4 v[180:183], v1, s[32:35], s7 offen
    s_add_u32 s7, s7, 8192
    s_and_b32 s7, s7, 262143
    s_waitcnt vmcnt(4)
    s_cbranch_vccnz L_lo14
    s_waitcnt vmcnt(2)
L_lo14:
    buffer_load_dwordx4 v[184:187], v1, s[32:35], s7 offen
    s_add_u32 s7, s7, 8192
    s_and_b32 s7, s7, 262143
    v_perm_b32 v64, v164, v160, s39
    v_perm_b32 v65, v164, v160, s40
    v_perm_b32 v66, v165, v161, s39
    v_perm_b32 v67, v165, v161, s40
    v_perm_b32 v68, v166, v162, s39
    v_perm_b32 v69, v166, v162, s40
    v_perm_b32 v70, v167, v163, s39
    v_perm_b32 v71, v167, v163, s40
    v_dot2c_f32_bf16_dpp v40, v36, v64 row_newbcast:4 row_mask:0xf bank_mask:0xf
    v_dot2c_f32_bf16_dpp v41, v36, v65 row_newbcast:4 row_mask:0xf bank_mask:0xf
    v_dot2c_f32_bf16_dpp v42, v36, v66 row_newbcast:4 row_mask:0xf bank_mask:0xf
    v_dot2c_f32_bf16_dpp v43, v36, v67 row_newbcast:4 row_mask:0xf bank_mask:0xf
    v_dot2c_f32_bf16_dpp v44, v36, v68 row_newbcast:4 row_mask:0xf bank_mask:0xf
    v_dot2c_f32_bf16_dpp v45, v36, v69 row_newbcast:4 row_mask:0xf bank_mask:0xf
    v_dot2c_f32_bf16_dpp v46, v36, v70 row_newbcast:4 row_mask:0xf bank_mask:0xf
    v_dot2c_f32_bf16_dpp v47, v36, v71 row_newbcast:4 row_mask:0xf bank_mask:0xf
    s_cbranch_vccz L_np14
    s_call_b64 s[56:57], L_lat
L_np14:
    s_cbranch_vccz L_nokf
    s_cmp_gt_i32 s59, 0
    s_cselect_b32 s88, 3, 1
    s_getreg_b32 s85, hwreg(HW_REG_XCC_ID)
    s_lshr_b32 s6, s85, 1
    s_xor_b32 s6, s6, s2
    s_and_b32 s6, s6, 2
    s_xor_b32 s88, s88, s6
    s_sub_u32 s85, s85, s96
    s_and_b32 s85, s85, 7
    s_lshl_b32 s85, s85, 2
    s_or_b32 s88, s88, s85
    s_add_u32 s89, s30, 128
    v_mov_b32 v60, s89
    v_mov_b32 v61, s88
    s_waitcnt vmcnt(0)
    s_mov_b64 exec, 1
    global_store_byte v60, v61, s[26:27] sc1
    s_mov_b64 exec, -1
L_nokf:
    s_waitcnt vmcnt(4)
    s_cbranch_vccnz L_lo15
    s_waitcnt vmcnt(2)
L_lo15:
    buffer_load_dwordx4 v[188:191], v1, s[32:35], s7 offen
    s_add_u32 s7, s7, 8192
    s_and_b32 s7, s7, 262143
    s_waitcnt vmcnt(4)
    s_cbranch_vccnz L_lo16
    s_waitcnt vmcnt(2)
L_lo16:
    buffer_load_dwordx4 v[192:195], v1, s[32:35], s7 offen
    s_add_u32 s7, s7, 8192
    s_and_b32 s7, s7, 262143
    v_perm_b32 v72, v172, v168, s39
    v_perm_b32 v73, v172, v168, s40
    v_perm_b32 v74, v173, v169, s39
    v_perm_b32 v75, v173, v169, s40
    v_perm_b32 v76, v174, v170, s39
    v_perm_b32 v77, v174, v170, s40
    v_perm_b32 v78, v175, v171, s39
    v_perm_b32 v79, v175, v171, s40
    v_dot2c_f32_bf16_dpp v40, v36, v72 row_newbcast:5 row_mask:0xf bank_mask:0xf
    v_dot2c_f32_bf16_dpp v41, v36, v73 row_newbcast:5 row_mask:0xf bank_mask:0xf
    v_dot2c_f32_bf16_dpp v42, v36, v74 row_newbcast:5 row_mask:0xf bank_mask:0xf
    v_dot2c_f32_bf16_dpp v43, v36, v75 row_newbcast:5 row_mask:0xf bank_mask:0xf
    v_dot2c_f32_bf16_dpp v44, v36, v76 row_newbcast:5 row_mask:0xf bank_mask:0xf
    v_dot2c_f32_bf16_dpp v45, v36, v77 row_newbcast:5 row_mask:0xf bank_mask:0xf
    v_dot2c_f32_bf16_dpp v46, v36, v78 row_newbcast:5 row_mask:0xf bank_mask:0xf
    v_dot2c_f32_bf16_dpp v47, v36, v79 row_newbcast:5 row_mask:0xf bank_mask:0xf
    s_waitcnt vmcnt(4)
    s_cbranch_vccnz L_lo17
    s_waitcnt vmcnt(2)
L_lo17:
    buffer_load_dwordx4 v[196:199], v1, s[32:35], s7 offen
    s_add_u32 s7, s7, 8192
    s_and_b32 s7, s7, 262143
    s_waitcnt vmcnt(4)
    s_cbranch_vccnz L_lo18
    s_waitcnt vmcnt(2)
L_lo18:
    buffer_load_dwordx4 v[200:203], v1, s[32:35], s7 offen
    s_add_u32 s7, s7, 8192
    s_and_b32 s7, s7, 262143
    v_perm_b32 v64, v180, v176, s39
    v_perm_b32 v65, v180, v176, s40
    v_perm_b32 v66, v181, v177, s39
    v_perm_b32 v67, v181, v177, s40
    v_perm_b32 v68, v182, v178, s39
    v_perm_b32 v69, v182, v178, s40
    v_perm_b32 v70, v183, v179, s39
    v_perm_b32 v71, v183, v179, s40
    v_dot2c_f32_bf16_dpp v40, v36, v64 row_newbcast:6 row_mask:0xf bank_mask:0xf
    v_dot2c_f32_bf16_dpp v41, v36, v65 row_newbcast:6 row_mask:0xf bank_mask:0xf
    v_dot2c_f32_bf16_dpp v42, v36, v66 row_newbcast:6 row_mask:0xf bank_mask:0xf
    v_dot2c_f32_bf16_dpp v43, v36, v67 row_newbcast:6 row_mask:0xf bank_mask:0xf
    v_dot2c_f32_bf16_dpp v44, v36, v68 row_newbcast:6 row_mask:0xf bank_mask:0xf
    v_dot2c_f32_bf16_dpp v45, v36, v69 row_newbcast:6 row_mask:0xf bank_mask:0xf
    v_dot2c_f32_bf16_dpp v46, v36, v70 row_newbcast:6 row_mask:0xf bank_mask:0xf
    v_dot2c_f32_bf16_dpp v47, v36, v71 row_newbcast:6 row_mask:0xf bank_mask:0xf
    s_waitcnt vmcnt(4)
    s_cbranch_vccnz L_lo19
    s_waitcnt vmcnt(2)
L_lo19:
    buffer_load_dwordx4 v[204:207], v1, s[32:35], s7 offen
    s_add_u32 s7, s7, 8192
    s_and_b32 s7, s7, 262143
    s_waitcnt vmcnt(4)
    s_cbranch_vccnz L_lo20
    s_waitcnt vmcnt(2)
L_lo20:
    buffer_load_dwordx4 v[208:211], v1, s[32:35], s7 offen
    s_add_u32 s7, s7, 8192
    s_and_b32 s7, s7, 262143
    v_perm_b32 v72, v188, v184, s39
    v_perm_b32 v73, v188, v184, s40
    v_perm_b32 v74, v189, v185, s39
    v_perm_b32 v75, v189, v185, s40
    v_perm_b32 v76, v190, v186, s39
    v_perm_b32 v77, v190, v186, s40
    v_perm_b32 v78, v191, v187, s39
    v_perm_b32 v79, v191, v187, s40
    v_dot2c_f32_bf16_dpp v40, v36, v72 row_newbcast:7 row_mask:0xf bank_mask:0xf
    v_dot2c_f32_bf16_dpp v41, v36, v73 row_newbcast:7 row_mask:0xf bank_mask:0xf
    v_dot2c_f32_bf16_dpp v42, v36, v74 row_newbcast:7 row_mask:0xf bank_mask:0xf
    v_dot2c_f32_bf16_dpp v43, v36, v75 row_newbcast:7 row_mask:0xf bank_mask:0xf
    v_dot2c_f32_bf16_dpp v44, v36, v76 row_newbcast:7 row_mask:0xf bank_mask:0xf
    v_dot2c_f32_bf16_dpp v45, v36, v77 row_newbcast:7 row_mask:0xf bank_mask:0xf
    v_dot2c_f32_bf16_dpp v46, v36, v78 row_newbcast:7 row_mask:0xf bank_mask:0xf
    v_dot2c_f32_bf16_dpp v47, v36, v79 row_newbcast:7 row_mask:0xf bank_mask:0xf
    s_waitcnt vmcnt(4)
    s_cbranch_vccnz L_lo21
    s_waitcnt vmcnt(2)
L_lo21:
    buffer_load_dwordx4 v[212:215], v1, s[32:35], s7 offen
    s_add_u32 s7, s7, 8192
    s_and_b32 s7, s7, 262143
    s_waitcnt vmcnt(4)
    s_cbranch_vccnz L_lo22
    s_waitcnt vmcnt(2)
L_lo22:
    buffer_load_dwordx4 v[216:219], v1, s[32:35], s7 offen
    s_add_u32 s7, s7, 8192
    s_and_b32 s7, s7, 262143
    v_perm_b32 v64, v196, v192, s39
    v_perm_b32 v65, v196, v192, s40
    v_perm_b32 v66, v197, v193, s39
    v_perm_b32 v67, v197, v193, s40
    v_perm_b32 v68, v198, v194, s39
    v_perm_b32 v69, v198, v194, s40
    v_perm_b32 v70, v199, v195, s39
    v_perm_b32 v71, v199, v195, s40
    v_dot2c_f32_bf16_dpp v40, v36, v64 row_newbcast:8 row_mask:0xf bank_mask:0xf
    v_dot2c_f32_bf16_dpp v41, v36, v65 row_newbcast:8 row_mask:0xf bank_mask:0xf
    v_dot2c_f32_bf16_dpp v42, v36, v66 row_newbcast:8 row_mask:0xf bank_mask:0xf
    v_dot2c_f32_bf16_dpp v43, v36, v67 row_newbcast:8 row_mask:0xf bank_mask:0xf
    v_dot2c_f32_bf16_dpp v44, v36, v68 row_newbcast:8 row_mask:0xf bank_mask:0xf
    v_dot2c_f32_bf16_dpp v45, v36, v69 row_newbcast:8 row_mask:0xf bank_mask:0xf
    v_dot2c_f32_bf16_dpp v46, v36, v70 row_newbcast:8 row_mask:0xf bank_mask:0xf
    v_dot2c_f32_bf16_dpp v47, v36, v71 row_newbcast:8 row_mask:0xf bank_mask:0xf
    s_waitcnt vmcnt(4)
    s_cbranch_vccnz L_lo23
    s_waitcnt vmcnt(2)
L_lo23:
    buffer_load_dwordx4 v[220:223], v1, s[32:35], s7 offen
    s_add_u32 s7, s7, 8192
    s_and_b32 s7, s7, 262143
    s_waitcnt vmcnt(4)
    s_cbranch_vccnz L_lo24
    s_waitcnt vmcnt(2)
L_lo24:
    buffer_load_dwordx4 v[224:227], v1, s[32:35], s7 offen
    s_add_u32 s7, s7, 8192
    s_and_b32 s7, s7, 262143
    v_perm_b32 v72, v204, v200, s39
    v_perm_b32 v73, v204, v200, s40
    v_perm_b32 v74, v205, v201, s39
    v_perm_b32 v75, v205, v201, s40
    v_perm_b32 v76, v206, v202, s39
    v_perm_b32 v77, v206, v202, s40
    v_perm_b32 v78, v207, v203, s39
    v_perm_b32 v79, v207, v203, s40
    v_dot2c_f32_bf16_dpp v40, v36, v72 row_newbcast:9 row_mask:0xf bank_mask:0xf
    v_dot2c_f32_bf16_dpp v41, v36, v73 row_newbcast:9 row_mask:0xf bank_mask:0xf
    v_dot2c_f32_bf16_dpp v42, v36, v74 row_newbcast:9 row_mask:0xf bank_mask:0xf
    v_dot2c_f32_bf16_dpp v43, v36, v75 row_newbcast:9 row_mask:0xf bank_mask:0xf
    v_dot2c_f32_bf16_dpp v44, v36, v76 row_newbcast:9 row_mask:0xf bank_mask:0xf
    v_dot2c_f32_bf16_dpp v45, v36, v77 row_newbcast:9 row_mask:0xf bank_mask:0xf
    v_dot2c_f32_bf16_dpp v46, v36, v78 row_newbcast:9 row_mask:0xf bank_mask:0xf
    v_dot2c_f32_bf16_dpp v47, v36, v79 row_newbcast:9 row_mask:0xf bank_mask:0xf
    s_waitcnt vmcnt(4)
    s_cbranch_vccnz L_lo25
    s_waitcnt vmcnt(2)
L_lo25:
    buffer_load_dwordx4 v[228:231], v1, s[32:35], s7 offen
    s_add_u32 s7, s7, 8192
    s_and_b32 s7, s7, 262143
    s_waitcnt vmcnt(4)
    s_cbranch_vccnz L_lo26
    s_waitcnt vmcnt(2)
L_lo26:
    buffer_load_dwordx4 v[232:235], v1, s[32:35], s7 offen
    s_add_u32 s7, s7, 8192
    s_and_b32 s7, s7, 262143
    v_perm_b32 v64, v212, v208, s39
    v_perm_b32 v65, v212, v208, s40
    v_perm_b32 v66, v213, v209, s39
    v_perm_b32 v67, v213, v209, s40
    v_perm_b32 v68, v214, v210, s39
    v_perm_b32 v69, v214, v210, s40
    v_perm_b32 v70, v215, v211, s39
    v_perm_b32 v71, v215, v211, s40
    v_dot2c_f32_bf16_dpp v40, v36, v64 row_newbcast:10 row_mask:0xf bank_mask:0xf
    v_dot2c_f32_bf16_dpp v41, v36, v65 row_newbcast:10 row_mask:0xf bank_mask:0xf
    v_dot2c_f32_bf16_dpp v42, v36, v66 row_newbcast:10 row_mask:0xf bank_mask:0xf
    v_dot2c_f32_bf16_dpp v43, v36, v67 row_newbcast:10 row_mask:0xf bank_mask:0xf
    v_dot2c_f32_bf16_dpp v44, v36, v68 row_newbcast:10 row_mask:0xf bank_mask:0xf
    v_dot2c_f32_bf16_dpp v45, v36, v69 row_newbcast:10 row_mask:0xf bank_mask:0xf
    v_dot2c_f32_bf16_dpp v46, v36, v70 row_newbcast:10 row_mask:0xf bank_mask:0xf
    v_dot2c_f32_bf16_dpp v47, v36, v71 row_newbcast:10 row_mask:0xf bank_mask:0xf
    s_waitcnt vmcnt(4)
    s_cbranch_vccnz L_lo27
    s_waitcnt vmcnt(2)
L_lo27:
    buffer_load_dwordx4 v[236:239], v1, s[32:35], s7 offen
    s_add_u32 s7, s7, 8192
    s_and_b32 s7, s7, 262143
    s_waitcnt vmcnt(4)
    s_cbranch_vccnz L_lo28
    s_waitcnt vmcnt(2)
L_lo28:
    buffer_load_dwordx4 v[240:243], v1, s[32:35], s7 offen
    s_add_u32 s7, s7, 8192
    s_and_b32 s7, s7, 262143
    v_perm_b32 v72, v220, v216, s39
    v_perm_b32 v73, v220, v216, s40
    v_perm_b32 v74, v221, v217, s39
    v_perm_b32 v75, v221, v217, s40
    v_perm_b32 v76, v222, v218, s39
    v_perm_b32 v77, v222, v218, s40
    v_perm_b32 v78, v223, v219, s39
    v_perm_b32 v79, v223, v219, s40
    v_dot2c_f32_bf16_dpp v40, v36, v72 row_newbcast:11 row_mask:0xf bank_mask:0xf
    v_dot2c_f32_bf16_dpp v41, v36, v73 row_newbcast:11 row_mask:0xf bank_mask:0xf
    v_dot2c_f32_bf16_dpp v42, v36, v74 row_newbcast:11 row_mask:0xf bank_mask:0xf
    v_dot2c_f32_bf16_dpp v43, v36, v75 row_newbcast:11 row_mask:0xf bank_mask:0xf
    v_dot2c_f32_bf16_dpp v44, v36, v76 row_newbcast:11 row_mask:0xf bank_mask:0xf
    v_dot2c_f32_bf16_dpp v45, v36, v77 row_newbcast:11 row_mask:0xf bank_mask:0xf
    v_dot2c_f32_bf16_dpp v46, v36, v78 row_newbcast:11 row_mask:0xf bank_mask:0xf
    v_dot2c_f32_bf16_dpp v47, v36, v79 row_newbcast:11 row_mask:0xf bank_mask:0xf
    s_waitcnt vmcnt(4)
    s_cbranch_vccnz L_lo29
    s_waitcnt vmcnt(2)
L_lo29:
    buffer_load_dwordx4 v[244:247], v1, s[32:35], s7 offen
    s_add_u32 s7, s7, 8192
    s_and_b32 s7, s7, 262143
    s_waitcnt vmcnt(4)
    s_cbranch_vccnz L_lo30
    s_waitcnt vmcnt(2)
L_lo30:
    buffer_load_dwordx4 v[248:251], v1, s[32:35], s7 offen
    s_add_u32 s7, s7, 8192
    s_and_b32 s7, s7, 262143
    v_perm_b32 v64, v228, v224, s39
    v_perm_b32 v65, v228, v224, s40
    v_perm_b32 v66, v229, v225, s39
    v_perm_b32 v67, v229, v225, s40
    v_perm_b32 v68, v230, v226, s39
    v_perm_b32 v69, v230, v226, s40
    v_perm_b32 v70, v231, v227, s39
    v_perm_b32 v71, v231, v227, s40
    v_dot2c_f32_bf16_dpp v40, v36, v64 row_newbcast:12 row_mask:0xf bank_mask:0xf
    v_dot2c_f32_bf16_dpp v41, v36, v65 row_newbcast:12 row_mask:0xf bank_mask:0xf
    v_dot2c_f32_bf16_dpp v42, v36, v66 row_newbcast:12 row_mask:0xf bank_mask:0xf
    v_dot2c_f32_bf16_dpp v43, v36, v67 row_newbcast:12 row_mask:0xf bank_mask:0xf
    v_dot2c_f32_bf16_dpp v44, v36, v68 row_newbcast:12 row_mask:0xf bank_mask:0xf
    v_dot2c_f32_bf16_dpp v45, v36, v69 row_newbcast:12 row_mask:0xf bank_mask:0xf
    v_dot2c_f32_bf16_dpp v46, v36, v70 row_newbcast:12 row_mask:0xf bank_mask:0xf
    v_dot2c_f32_bf16_dpp v47, v36, v71 row_newbcast:12 row_mask:0xf bank_mask:0xf
    s_waitcnt vmcnt(4)
    s_cbranch_vccnz L_lo31
    s_waitcnt vmcnt(2)
L_lo31:
    buffer_load_dwordx4 v[252:255], v1, s[32:35], s7 offen
    s_waitcnt vmcnt(4)
    v_perm_b32 v72, v236, v232, s39
    v_perm_b32 v73, v236, v232, s40
    v_perm_b32 v74, v237, v233, s39
    v_perm_b32 v75, v237, v233, s40
    v_perm_b32 v76, v238, v234, s39
    v_perm_b32 v77, v238, v234, s40
    v_perm_b32 v78, v239, v235, s39
    v_perm_b32 v79, v239, v235, s40
    v_dot2c_f32_bf16_dpp v40, v36, v72 row_newbcast:13 row_mask:0xf bank_mask:0xf
    v_dot2c_f32_bf16_dpp v41, v36, v73 row_newbcast:13 row_mask:0xf bank_mask:0xf
    v_dot2c_f32_bf16_dpp v42, v36, v74 row_newbcast:13 row_mask:0xf bank_mask:0xf
    v_dot2c_f32_bf16_dpp v43, v36, v75 row_newbcast:13 row_mask:0xf bank_mask:0xf
    v_dot2c_f32_bf16_dpp v44, v36, v76 row_newbcast:13 row_mask:0xf bank_mask:0xf
    v_dot2c_f32_bf16_dpp v45, v36, v77 row_newbcast:13 row_mask:0xf bank_mask:0xf
    v_dot2c_f32_bf16_dpp v46, v36, v78 row_newbcast:13 row_mask:0xf bank_mask:0xf
    v_dot2c_f32_bf16_dpp v47, v36, v79 row_newbcast:13 row_mask:0xf bank_mask:0xf
    s_waitcnt vmcnt(2)
    v_perm_b32 v64, v244, v240, s39
    v_perm_b32 v65, v244, v240, s40
    v_perm_b32 v66, v245, v241, s39
    v_perm_b32 v67, v245, v241, s40
    v_perm_b32 v68, v246, v242, s39
    v_perm_b32 v69, v246, v242, s40
    v_perm_b32 v70, v247, v243, s39
    v_perm_b32 v71, v247, v243, s40
    v_dot2c_f32_bf16_dpp v40, v36, v64 row_newbcast:14 row_mask:0xf bank_mask:0xf
    v_dot2c_f32_bf16_dpp v41, v36, v65 row_newbcast:14 row_mask:0xf bank_mask:0xf
    v_dot2c_f32_bf16_dpp v42, v36, v66 row_newbcast:14 row_mask:0xf bank_mask:0xf
    v_dot2c_f32_bf16_dpp v43, v36, v67 row_newbcast:14 row_mask:0xf bank_mask:0xf
    v_dot2c_f32_bf16_dpp v44, v36, v68 row_newbcast:14 row_mask:0xf bank_mask:0xf
    v_dot2c_f32_bf16_dpp v45, v36, v69 row_newbcast:14 row_mask:0xf bank_mask:0xf
    v_dot2c_f32_bf16_dpp v46, v36, v70 row_newbcast:14 row_mask:0xf bank_mask:0xf
    v_dot2c_f32_bf16_dpp v47, v36, v71 row_newbcast:14 row_mask:0xf bank_mask:0xf
    s_waitcnt vmcnt(0)
    v_perm_b32 v72, v252, v248, s39
    v_perm_b32 v73, v252, v248, s40
    v_perm_b32 v74, v253, v249, s39
    v_perm_b32 v75, v253, v249, s40
    v_perm_b32 v76, v254, v250, s39
    v_perm_b32 v77, v254, v250, s40
    v_perm_b32 v78, v255, v251, s39
    v_perm_b32 v79, v255, v251, s40
    v_dot2c_f32_bf16_dpp v40, v36, v72 row_newbcast:15 row_mask:0xf bank_mask:0xf
    v_dot2c_f32_bf16_dpp v41, v36, v73 row_newbcast:15 row_mask:0xf bank_mask:0xf
    v_dot2c_f32_bf16_dpp v42, v36, v74 row_newbcast:15 row_mask:0xf bank_mask:0xf
    v_dot2c_f32_bf16_dpp v43, v36, v75 row_newbcast:15 row_mask:0xf bank_mask:0xf
    v_dot2c_f32_bf16_dpp v44, v36, v76 row_newbcast:15 row_mask:0xf bank_mask:0xf
    v_dot2c_f32_bf16_dpp v45, v36, v77 row_newbcast:15 row_mask:0xf bank_mask:0xf
    v_dot2c_f32_bf16_dpp v46, v36, v78 row_newbcast:15 row_mask:0xf bank_mask:0xf
    v_dot2c_f32_bf16_dpp v47, v36, v79 row_newbcast:15 row_mask:0xf bank_mask:0xf
    v_permlane32_swap_b32 v40, v44
    v_permlane32_swap_b32 v41, v45
    v_permlane32_swap_b32 v42, v46
    v_permlane32_swap_b32 v43, v47
    v_add_f32 v40, v40, v44
    v_add_f32 v41, v41, v45
    v_add_f32 v42, v42, v46
    v_add_f32 v43, v43, v47
    s_nop 0
    v_permlane16_swap_b32 v40, v42
    v_permlane16_swap_b32 v41, v43
    v_add_f32 v40, v40, v42
    v_add_f32 v41, v41, v43
    ds_write_b64 v38, v[40:41] offset:0
    s_lshl_b32 s6, s3, 2
    v_mov_b32 v38, s6
    v_mov_b32 v37, 1
    s_waitcnt lgkmcnt(0)
    ds_write_b32 v38, v37 offset:4240
    buffer_load_dwordx4 v[128:131], v0, s[92:95], s91 offen
    buffer_load_dwordx4 v[132:135], v0, s[92:95], s91 offen offset:1024
    buffer_load_dwordx4 v[136:139], v0, s[92:95], s91 offen offset:2048
    buffer_load_dwordx4 v[140:143], v0, s[92:95], s91 offen offset:3072
    s_and_b32 s6, s30, 4
    v_mov_b32 v6, s6
    v_mul_u32_u24 v7, 56, v5
    s_mov_b32 s50, 3584
    s_mov_b32 s51, 0x20000
    s_mov_b32 s48, s16
    s_mov_b32 s49, s17
    buffer_load_dwordx4 v[158:161], v7, s[48:51], 0 offen
    buffer_load_dwordx4 v[162:165], v7, s[48:51], 0 offen offset:16
    buffer_load_dwordx4 v[166:169], v7, s[48:51], 0 offen offset:32
    buffer_load_dwordx2 v[170:171], v7, s[48:51], 0 offen offset:48
    s_mov_b32 s48, s18
    s_mov_b32 s49, s19
    buffer_load_dwordx4 v[186:189], v7, s[48:51], 0 offen
    buffer_load_dwordx4 v[190:193], v7, s[48:51], 0 offen offset:16
    buffer_load_dwordx4 v[194:197], v7, s[48:51], 0 offen offset:32
    buffer_load_dwordx2 v[198:199], v7, s[48:51], 0 offen offset:48
    s_mov_b32 s48, s20
    s_mov_b32 s49, s21
    buffer_load_dwordx4 v[200:203], v7, s[48:51], 0 offen
    buffer_load_dwordx4 v[204:207], v7, s[48:51], 0 offen offset:16
    buffer_load_dwordx4 v[208:211], v7, s[48:51], 0 offen offset:32
    buffer_load_dwordx2 v[212:213], v7, s[48:51], 0 offen offset:48
    s_mov_b32 s48, s22
    s_mov_b32 s49, s23
    s_mov_b32 s50, 2
    v_mov_b32 v7, 0
    buffer_load_ushort v48, v7, s[48:51], 0 offen
    v_and_b32 v7, 3, v3
    v_lshl_add_u32 v7, v7, 2, v2
    v_lshl_add_u32 v49, v7, 1, s5
    v_lshlrev_b32 v51, 2, v7
    buffer_load_ushort v50, v49, s[8:11], 0 offen
    s_mov_b32 s42, 2
    s_mov_b32 s41, 1577216
    s_mov_b32 s43, 0
    s_mov_b32 s4, 0
    s_mov_b32 s19, 0
    s_mov_b32 s59, -1
    v_and_b32 v58, 31, v5
    v_lshlrev_b32 v58, 4, v58
    v_lshlrev_b32 v62, 3, v5
    s_lshr_b32 s6, s2, 3
    s_mul_i32 s6, s6, 2048
    s_add_u32 s6, s6, 523264
    s_and_b32 s83, s2, 4
    s_lshl_b32 s83, s83, 8
    s_add_u32 s86, s6, s83
    v_add_u32 v59, s86, v58
    s_xor_b32 s83, s83, 1024
    s_add_u32 s86, s6, s83
    v_add_u32 v63, s86, v58
    s_mov_b32 s80, 4
    s_mov_b32 s81, 0
    s_mov_b32 s82, 0
    v_mov_b32 v64, 0
    v_mov_b32 v65, 0
    ds_write_b64 v62, v[64:65] offset:9728
    s_lshr_b32 s6, s2, 3
    s_and_b32 s83, s96, 3
    s_add_u32 s6, s6, s83
    s_and_b32 s6, s6, 3
    s_lshl_b32 s6, s6, 2
    s_or_b32 s6, s6, s3
    s_cmp_lg_u32 s6, 2
    s_cbranch_scc1 L_nok0
    s_mov_b32 s7, 0
    s_and_b32 s6, s30, 4
    s_add_u32 s6, s6, 128
    s_load_dword s87, s[26:27], s6
    s_waitcnt lgkmcnt(0)
L_fwk:
    s_and_b32 s6, s30, 3
    s_lshl_b32 s6, s6, 3
    s_lshr_b32 s87, s87, s6
    s_bitcmp1_b32 s87, 0
    s_cbranch_scc1 L_fok
    s_sleep 8
    v_mov_b32 v53, 8
    s_mov_b64 exec, 1
    global_load_dword v52, v6, s[26:27] offset:128 sc1
    s_mov_b64 exec, -1
    s_waitcnt vmcnt(0)
    v_readfirstlane_b32 s87, v52
    s_add_u32 s7, s7, 1
    s_cmp_lt_u32 s7, 0x400000
    s_cbranch_scc1 L_fwk
L_fok:
    s_lshr_b32 s6, s87, 2
    s_add_u32 s6, s6, s96
    s_lshr_b32 s6, s6, 1
    s_xor_b32 s6, s6, s2
    s_xor_b32 s6, s6, s87
    s_lshr_b32 s6, s6, 1
    s_xor_b32 s6, s6, 1
    s_and_b32 s6, s6, 1
    s_or_b32 s6, s6, 2
    v_mov_b32 v52, s6
    ds_write_b32 v56, v52 offset:248
L_xq:
    ds_read_b128 v[52:55], v56 offset:144
    ds_read_b64 v[64:65], v62 offset:0
    ds_read_b64 v[66:67], v62 offset:512
    ds_read_b64 v[68:69], v62 offset:1024
    ds_read_b64 v[70:71], v62 offset:1536
    s_waitcnt lgkmcnt(0)
    v_min_u32 v52, v52, v53
    v_min3_u32 v52, v52, v54, v55
    s_nop 0
    v_readfirstlane_b32 s6, v52
    s_nop 0
    s_cmp_eq_u32 s6, 0
    s_cbranch_scc1 L_xq
    v_pk_add_f32 v[64:65], v[64:65], v[66:67]
    v_pk_add_f32 v[68:69], v[68:69], v[70:71]
    v_pk_add_f32 v[64:65], v[64:65], v[68:69]
    v_cvt_pk_bf16_f32 v64, v64, v65
    v_mov_b32 v65, 0
    ds_write_b64 v62, v[64:65] offset:10240
    s_mov_b32 s80, 0
    s_call_b64 s[84:85], L_svc
L_nok0:
    v_sub_f32 v16, v16, v34
    v_sub_f32 v17, v17, v34
    v_sub_f32 v18, v18, v34
    v_sub_f32 v19, v19, v34
    v_sub_f32 v20, v20, v34
    v_sub_f32 v21, v21, v34
    v_sub_f32 v22, v22, v34
    v_sub_f32 v23, v23, v34
    v_cvt_pk_bf16_f32 v16, v16, v17
    v_cvt_pk_bf16_f32 v18, v18, v19
    v_cvt_pk_bf16_f32 v20, v20, v21
    v_cvt_pk_bf16_f32 v22, v22, v23
    v_and_b32 v17, s36, v16
    v_lshlrev_b32 v16, 16, v16
    v_and_b32 v19, s36, v18
    v_lshlrev_b32 v18, 16, v18
    v_and_b32 v21, s36, v20
    v_lshlrev_b32 v20, 16, v20
    v_and_b32 v23, s36, v22
    v_lshlrev_b32 v22, 16, v22
    v_mul_f32 v16, v16, v35
    v_mul_f32 v17, v17, v35
    v_mul_f32 v18, v18, v35
    v_mul_f32 v19, v19, v35
    v_mul_f32 v20, v20, v35
    v_mul_f32 v21, v21, v35
    v_mul_f32 v22, v22, v35
    v_mul_f32 v23, v23, v35
    v_cvt_pk_bf16_f32 v16, v16, v17
    v_cvt_pk_bf16_f32 v18, v18, v19
    v_cvt_pk_bf16_f32 v20, v20, v21
    v_cvt_pk_bf16_f32 v22, v22, v23
    v_and_b32 v17, s36, v16
    v_lshlrev_b32 v16, 16, v16
    v_and_b32 v19, s36, v18
    v_lshlrev_b32 v18, 16, v18
    v_and_b32 v21, s36, v20
    v_lshlrev_b32 v20, 16, v20
    v_and_b32 v23, s36, v22
    v_lshlrev_b32 v22, 16, v22
    v_lshlrev_b32 v8, 16, v14
    v_and_b32 v9, s36, v14
    v_lshlrev_b32 v10, 16, v15
    v_and_b32 v11, s36, v15
    v_sub_f32 v8, v8, v34
    v_sub_f32 v9, v9, v34
    v_sub_f32 v10, v10, v34
    v_sub_f32 v11, v11, v34
    v_cvt_pk_bf16_f32 v8, v8, v9
    v_cvt_pk_bf16_f32 v10, v10, v11
    v_and_b32 v9, s36, v8
    v_lshlrev_b32 v8, 16, v8
    v_and_b32 v11, s36, v10
    v_lshlrev_b32 v10, 16, v10
    v_mul_f32 v8, v8, v35
    v_mul_f32 v9, v9, v35
    v_mul_f32 v10, v10, v35
    v_mul_f32 v11, v11, v35
    v_cvt_pk_bf16_f32 v8, v8, v9
    v_cvt_pk_bf16_f32 v10, v10, v11
    v_and_b32 v9, s36, v8
    v_lshlrev_b32 v8, 16, v8
    v_and_b32 v11, s36, v10
    v_lshlrev_b32 v10, 16, v10
    v_add_f32 v24, v16, v17
    v_add_f32 v25, v18, v19
    v_add_f32 v26, v20, v21
    v_add_f32 v27, v22, v23
    v_add_f32 v24, v24, v25
    v_add_f32 v26, v26, v27
    v_add_f32 v24, v24, v26
    s_nop 1
    v_add_f32_dpp v24, v24, v24 row_ror:8 row_mask:0xf bank_mask:0xf
    s_nop 1
    v_add_f32_dpp v24, v24, v24 row_ror:4 row_mask:0xf bank_mask:0xf
    s_nop 1
    v_add_f32_dpp v24, v24, v24 row_ror:2 row_mask:0xf bank_mask:0xf
    s_nop 1
    v_add_f32_dpp v24, v24, v24 row_ror:1 row_mask:0xf bank_mask:0xf
    v_mov_b32 v25, v24
    s_nop 1
    v_permlane16_swap_b32 v24, v25
    v_add_f32 v24, v24, v25
    v_mov_b32 v25, v24
    s_nop 1
    v_permlane32_swap_b32 v24, v25
    v_add_f32 v24, v24, v25
    v_mul_f32 v24, s37, v24
    v_sub_f32 v26, v16, v24
    v_sub_f32 v27, v17, v24
    v_sub_f32 v28, v18, v24
    v_sub_f32 v29, v19, v24
    v_sub_f32 v30, v20, v24
    v_sub_f32 v31, v21, v24
    v_sub_f32 v32, v22, v24
    v_sub_f32 v33, v23, v24
    v_mul_f32 v25, v26, v26
    v_fmac_f32 v25, v27, v27
    v_fmac_f32 v25, v28, v28
    v_fmac_f32 v25, v29, v29
    v_fmac_f32 v25, v30, v30
    v_fmac_f32 v25, v31, v31
    v_fmac_f32 v25, v32, v32
    v_fmac_f32 v25, v33, v33
    s_nop 1
    v_add_f32_dpp v25, v25, v25 row_ror:8 row_mask:0xf bank_mask:0xf
    s_nop 1
    v_add_f32_dpp v25, v25, v25 row_ror:4 row_mask:0xf bank_mask:0xf
    s_nop 1
    v_add_f32_dpp v25, v25, v25 row_ror:2 row_mask:0xf bank_mask:0xf
    s_nop 1
    v_add_f32_dpp v25, v25, v25 row_ror:1 row_mask:0xf bank_mask:0xf
    v_mov_b32 v26, v25
    s_nop 1
    v_permlane16_swap_b32 v25, v26
    v_add_f32 v25, v25, v26
    v_mov_b32 v26, v25
    s_nop 1
    v_permlane32_swap_b32 v25, v26
    v_add_f32 v25, v25, v26
    v_mul_f32 v25, s37, v25
    v_cvt_pk_bf16_f32 v34, v24, v24
    v_and_b32 v34, s36, v34
    v_cvt_pk_bf16_f32 v25, v25, v25
    v_and_b32 v25, s36, v25
    v_add_f32 v25, s38, v25
    v_cvt_pk_bf16_f32 v25, v25, v25
    v_and_b32 v25, s36, v25
    v_sqrt_f32 v25, v25
    s_nop 0
    v_cvt_pk_bf16_f32 v25, v25, v25
    v_and_b32 v25, s36, v25
    v_rcp_f32 v35, v25
    v_sub_f32 v8, v8, v34
    v_sub_f32 v9, v9, v34
    v_sub_f32 v10, v10, v34
    v_sub_f32 v11, v11, v34
    v_cvt_pk_bf16_f32 v8, v8, v9
    v_cvt_pk_bf16_f32 v10, v10, v11
    v_and_b32 v9, s36, v8
    v_lshlrev_b32 v8, 16, v8
    v_and_b32 v11, s36, v10
    v_lshlrev_b32 v10, 16, v10
    v_mul_f32 v8, v8, v35
    v_mul_f32 v9, v9, v35
    v_mul_f32 v10, v10, v35
    v_mul_f32 v11, v11, v35
    v_cvt_pk_bf16_f32 v8, v8, v9
    v_cvt_pk_bf16_f32 v10, v10, v11
    v_and_b32 v9, s36, v8
    v_lshlrev_b32 v8, 16, v8
    v_and_b32 v11, s36, v10
    v_lshlrev_b32 v10, 16, v10
    s_call_b64 s[56:57], L_step
    s_mov_b32 s20, 0xcccccccc
    s_mov_b32 s21, 0xcccccccc
    s_mov_b32 s22, 0xaaaaaaaa
    s_mov_b32 s23, 0xaaaaaaaa
    s_mov_b32 s16, 0x3db504f3
    v_lshlrev_b32 v236, 5, v3
    s_lshl_b32 s6, s3, 15
    s_add_u32 s6, s6, 14336
    v_lshl_add_u32 v57, v5, 4, s6
    v_mov_b32 v237, v57
    s_waitcnt lgkmcnt(0)
    ds_read_b128 v[64:67], v236 offset:0
    ds_read_b128 v[68:71], v236 offset:16
    ds_read_b128 v[72:75], v236 offset:512
    ds_read_b128 v[76:79], v236 offset:528
    ds_read_b128 v[80:83], v236 offset:1024
    ds_read_b128 v[84:87], v236 offset:1040
    ds_read_b128 v[88:91], v236 offset:1536
    ds_read_b128 v[92:95], v236 offset:1552
    s_waitcnt lgkmcnt(4)
    v_add_f32 v64, v64, v72
    v_add_f32 v65, v65, v73
    v_add_f32 v66, v66, v74
    v_add_f32 v67, v67, v75
    v_add_f32 v68, v68, v76
    v_add_f32 v69, v69, v77
    v_add_f32 v70, v70, v78
    v_add_f32 v71, v71, v79
    s_waitcnt lgkmcnt(0)
    v_add_f32 v80, v80, v88
    v_add_f32 v81, v81, v89
    v_add_f32 v82, v82, v90
    v_add_f32 v83, v83, v91
    v_add_f32 v84, v84, v92
    v_add_f32 v85, v85, v93
    v_add_f32 v86, v86, v94
    v_add_f32 v87, v87, v95
    v_add_f32 v64, v64, v80
    v_add_f32 v65, v65, v81
    v_add_f32 v66, v66, v82
    v_add_f32 v67, v67, v83
    v_add_f32 v68, v68, v84
    v_add_f32 v69, v69, v85
    v_add_f32 v70, v70, v86
    v_add_f32 v71, v71, v87
    v_cvt_pk_bf16_f32 v232, v64, v65
    v_cvt_pk_bf16_f32 v233, v66, v67
    v_cvt_pk_bf16_f32 v234, v68, v69
    v_cvt_pk_bf16_f32 v235, v70, v71
    s_mov_b32 s7, 0
L_lk:
    ds_read_b128 v[64:67], v237 offset:0
    ds_read_b128 v[68:71], v237 offset:1024
    ds_read_b128 v[72:75], v237 offset:2048
    ds_read_b128 v[76:79], v237 offset:3072
    ds_read_b128 v[80:83], v237 offset:4096
    ds_read_b128 v[84:87], v237 offset:5120
    ds_read_b128 v[88:91], v237 offset:6144
    ds_read_b128 v[92:95], v237 offset:7168
    s_waitcnt lgkmcnt(0)
    v_dot2_f32_bf16 v216, v64, v232, 0
    v_dot2_f32_bf16 v216, v65, v233, v216
    v_dot2_f32_bf16 v216, v66, v234, v216
    v_dot2_f32_bf16 v216, v67, v235, v216
    v_dot2_f32_bf16 v217, v68, v232, 0
    v_dot2_f32_bf16 v217, v69, v233, v217
    v_dot2_f32_bf16 v217, v70, v234, v217
    v_dot2_f32_bf16 v217, v71, v235, v217
    v_dot2_f32_bf16 v218, v72, v232, 0
    v_dot2_f32_bf16 v218, v73, v233, v218
    v_dot2_f32_bf16 v218, v74, v234, v218
    v_dot2_f32_bf16 v218, v75, v235, v218
    v_dot2_f32_bf16 v219, v76, v232, 0
    v_dot2_f32_bf16 v219, v77, v233, v219
    v_dot2_f32_bf16 v219, v78, v234, v219
    v_dot2_f32_bf16 v219, v79, v235, v219
    v_dot2_f32_bf16 v220, v80, v232, 0
    v_dot2_f32_bf16 v220, v81, v233, v220
    v_dot2_f32_bf16 v220, v82, v234, v220
    v_dot2_f32_bf16 v220, v83, v235, v220
    v_dot2_f32_bf16 v221, v84, v232, 0
    v_dot2_f32_bf16 v221, v85, v233, v221
    v_dot2_f32_bf16 v221, v86, v234, v221
    v_dot2_f32_bf16 v221, v87, v235, v221
    v_dot2_f32_bf16 v222, v88, v232, 0
    v_dot2_f32_bf16 v222, v89, v233, v222
    v_dot2_f32_bf16 v222, v90, v234, v222
    v_dot2_f32_bf16 v222, v91, v235, v222
    v_dot2_f32_bf16 v223, v92, v232, 0
    v_dot2_f32_bf16 v223, v93, v233, v223
    v_dot2_f32_bf16 v223, v94, v234, v223
    v_dot2_f32_bf16 v223, v95, v235, v223
    ds_read_b128 v[96:99], v237 offset:8192
    ds_read_b128 v[100:103], v237 offset:9216
    ds_read_b128 v[104:107], v237 offset:10240
    ds_read_b128 v[108:111], v237 offset:11264
    ds_read_b128 v[112:115], v237 offset:12288
    ds_read_b128 v[116:119], v237 offset:13312
    ds_read_b128 v[120:123], v237 offset:14336
    ds_read_b128 v[124:127], v237 offset:15360
    s_waitcnt lgkmcnt(0)
    v_dot2_f32_bf16 v224, v96, v232, 0
    v_dot2_f32_bf16 v224, v97, v233, v224
    v_dot2_f32_bf16 v224, v98, v234, v224
    v_dot2_f32_bf16 v224, v99, v235, v224
    v_dot2_f32_bf16 v225, v100, v232, 0
    v_dot2_f32_bf16 v225, v101, v233, v225
    v_dot2_f32_bf16 v225, v102, v234, v225
    v_dot2_f32_bf16 v225, v103, v235, v225
    v_add_f32_dpp v216, v216, v216 row_ror:8 row_mask:0xf bank_mask:0x3
    v_add_f32_dpp v216, v224, v224 row_ror:8 row_mask:0xf bank_mask:0xc
    v_dot2_f32_bf16 v226, v104, v232, 0
    v_dot2_f32_bf16 v226, v105, v233, v226
    v_dot2_f32_bf16 v226, v106, v234, v226
    v_dot2_f32_bf16 v226, v107, v235, v226
    v_add_f32_dpp v217, v217, v217 row_ror:8 row_mask:0xf bank_mask:0x3
    v_add_f32_dpp v217, v225, v225 row_ror:8 row_mask:0xf bank_mask:0xc
    v_dot2_f32_bf16 v227, v108, v232, 0
    v_dot2_f32_bf16 v227, v109, v233, v227
    v_dot2_f32_bf16 v227, v110, v234, v227
    v_dot2_f32_bf16 v227, v111, v235, v227
    v_add_f32_dpp v218, v218, v218 row_ror:8 row_mask:0xf bank_mask:0x3
    v_add_f32_dpp v218, v226, v226 row_ror:8 row_mask:0xf bank_mask:0xc
    v_dot2_f32_bf16 v228, v112, v232, 0
    v_dot2_f32_bf16 v228, v113, v233, v228
    v_dot2_f32_bf16 v228, v114, v234, v228
    v_dot2_f32_bf16 v228, v115, v235, v228
    v_add_f32_dpp v219, v219, v219 row_ror:8 row_mask:0xf bank_mask:0x3
    v_add_f32_dpp v219, v227, v227 row_ror:8 row_mask:0xf bank_mask:0xc
    v_dot2_f32_bf16 v229, v116, v232, 0
    v_dot2_f32_bf16 v229, v117, v233, v229
    v_dot2_f32_bf16 v229, v118, v234, v229
    v_dot2_f32_bf16 v229, v119, v235, v229
    v_add_f32_dpp v220, v220, v220 row_ror:8 row_mask:0xf bank_mask:0x3
    v_add_f32_dpp v220, v228, v228 row_ror:8 row_mask:0xf bank_mask:0xc
    v_dot2_f32_bf16 v230, v120, v232, 0
    v_dot2_f32_bf16 v230, v121, v233, v230
    v_dot2_f32_bf16 v230, v122, v234, v230
    v_dot2_f32_bf16 v230, v123, v235, v230
    v_add_f32_dpp v221, v221, v221 row_ror:8 row_mask:0xf bank_mask:0x3
    v_add_f32_dpp v221, v229, v229 row_ror:8 row_mask:0xf bank_mask:0xc
    v_dot2_f32_bf16 v231, v124, v232, 0
    v_dot2_f32_bf16 v231, v125, v233, v231
    v_dot2_f32_bf16 v231, v126, v234, v231
    v_dot2_f32_bf16 v231, v127, v235, v231
    v_add_f32_dpp v222, v222, v222 row_ror:8 row_mask:0xf bank_mask:0x3
    v_add_f32_dpp v222, v230, v230 row_ror:8 row_mask:0xf bank_mask:0xc
    v_mov_b32 v238, v239
    v_add_f32_dpp v216, v216, v216 row_half_mirror row_mask:0xf bank_mask:0x5
    v_add_f32_dpp v216, v220, v220 row_half_mirror row_mask:0xf bank_mask:0xa
    v_add_f32_dpp v217, v217, v217 row_half_mirror row_mask:0xf bank_mask:0x5
    v_add_f32_dpp v217, v221, v221 row_half_mirror row_mask:0xf bank_mask:0xa
    v_add_f32_dpp v223, v223, v223 row_ror:8 row_mask:0xf bank_mask:0x3
    v_add_f32_dpp v223, v231, v231 row_ror:8 row_mask:0xf bank_mask:0xc
    v_add_f32_dpp v218, v218, v218 row_half_mirror row_mask:0xf bank_mask:0x5
    v_add_f32_dpp v218, v222, v222 row_half_mirror row_mask:0xf bank_mask:0xa
    v_add_f32_dpp v219, v219, v219 row_half_mirror row_mask:0xf bank_mask:0x5
    v_add_f32_dpp v219, v223, v223 row_half_mirror row_mask:0xf bank_mask:0xa
    v_add_f32_dpp v216, v216, v216 quad_perm:[2,3,0,1] row_mask:0xf bank_mask:0xf
    v_add_f32_dpp v217, v217, v217 quad_perm:[2,3,0,1] row_mask:0xf bank_mask:0xf
    v_add_f32_dpp v218, v218, v218 quad_perm:[2,3,0,1] row_mask:0xf bank_mask:0xf
    v_add_f32_dpp v219, v219, v219 quad_perm:[2,3,0,1] row_mask:0xf bank_mask:0xf
    v_cndmask_b32 v216, v216, v218, s[20:21]
    v_cndmask_b32 v217, v217, v219, s[20:21]
    s_nop 0
    v_add_f32_dpp v216, v216, v216 quad_perm:[1,0,3,2] row_mask:0xf bank_mask:0xf
    v_add_f32_dpp v217, v217, v217 quad_perm:[1,0,3,2] row_mask:0xf bank_mask:0xf
    v_cndmask_b32 v216, v216, v217, s[22:23]
    v_cvt_pk_bf16_f32 v239, v216, v216
    v_and_b32 v239, s36, v239
    v_mul_f32 v239, s16, v239
    v_cvt_pk_bf16_f32 v239, v239, v239
    v_and_b32 v239, s36, v239
    v_add_u32 v237, 0x4000, v237
    s_add_u32 s7, s7, 1
    s_cmp_lt_u32 s7, 2
    s_cbranch_scc1 L_lk
    s_lshl_b32 s6, s3, 9
    v_lshl_add_u32 v236, v5, 3, s6
    ds_write_b64 v236, v[238:239] offset:5120
    s_waitcnt lgkmcnt(0)
    ds_write_b32 v38, v37 offset:4256
    s_add_u32 s16, s44, 0x1c0000
    s_addc_u32 s17, s45, 0
    s_mov_b32 s89, 8
    s_lshl_b32 s6, s2, 2
    s_or_b32 s6, s6, s3
    s_cmp_eq_u32 s6, 33
    s_cbranch_scc1 L_doprobe
    s_lshl_b32 s7, s2, 20
    s_add_u32 s16, s54, s7
    s_addc_u32 s17, s55, 0
    s_mov_b32 s89, s30
    s_mul_i32 s7, s30, 132
    s_add_u32 s7, s7, 35
    s_cmp_eq_u32 s6, s7
    s_cbranch_scc0 L_noprobe
L_doprobe:
    s_mov_b32 s88, 0
    s_mov_b32 s7, 0
L_probe:
    s_memtime s[80:81]
    s_waitcnt lgkmcnt(0)
    s_load_dword s84, s[16:17], s7
    s_waitcnt lgkmcnt(0)
    s_memtime s[82:83]
    s_waitcnt lgkmcnt(0)
    s_sub_u32 s85, s82, s80
    s_xor_b32 s7, s7, 0x2000
    s_memtime s[80:81]
    s_waitcnt lgkmcnt(0)
    s_load_dword s84, s[16:17], s7
    s_waitcnt lgkmcnt(0)
    s_memtime s[82:83]
    s_waitcnt lgkmcnt(0)
    s_sub_u32 s86, s82, s80
    s_xor_b32 s7, s7, 0x2000
    s_cmp_lt_u32 s86, s85
    s_addc_u32 s88, s88, 0
    s_add_u32 s7, s7, 256
    s_cmp_lt_u32 s7, 2816
    s_cbranch_scc1 L_probe
    s_cmp_gt_u32 s88, 5
    s_cselect_b32 s88, 3, 1
    s_getreg_b32 s85, hwreg(HW_REG_XCC_ID)
    s_lshr_b32 s6, s85, 1
    s_xor_b32 s6, s6, s2
    s_and_b32 s6, s6, 2
    s_xor_b32 s88, s88, s6
    s_sub_u32 s85, s85, s96
    s_and_b32 s85, s85, 7
    s_lshl_b32 s85, s85, 2
    s_or_b32 s88, s88, s85
    v_mov_b32 v60, s89
    v_mov_b32 v61, s88
    s_waitcnt vmcnt(63)
    s_mov_b64 exec, 1
    global_store_byte v60, v61, s[26:27] sc1
    s_mov_b64 exec, -1
L_noprobe:
    s_waitcnt vmcnt(0)
    v_lshlrev_b32 v144, 16, v158
    v_and_b32 v145, s36, v158
    v_lshlrev_b32 v146, 16, v159
    v_and_b32 v147, s36, v159
    v_lshlrev_b32 v148, 16, v160
    v_and_b32 v149, s36, v160
    v_lshlrev_b32 v150, 16, v161
    v_and_b32 v151, s36, v161
    v_lshlrev_b32 v152, 16, v162
    v_and_b32 v153, s36, v162
    v_lshlrev_b32 v154, 16, v163
    v_and_b32 v155, s36, v163
    v_lshlrev_b32 v156, 16, v164
    v_and_b32 v157, s36, v164
    v_lshlrev_b32 v158, 16, v165
    v_and_b32 v159, s36, v165
    v_lshlrev_b32 v160, 16, v166
    v_and_b32 v161, s36, v166
    v_lshlrev_b32 v162, 16, v167
    v_and_b32 v163, s36, v167
    v_lshlrev_b32 v164, 16, v168
    v_and_b32 v165, s36, v168
    v_lshlrev_b32 v166, 16, v169
    v_and_b32 v167, s36, v169
    v_lshlrev_b32 v168, 16, v170
    v_and_b32 v169, s36, v170
    v_lshlrev_b32 v170, 16, v171
    v_and_b32 v171, s36, v171
    v_lshlrev_b32 v172, 16, v186
    v_and_b32 v173, s36, v186
    v_lshlrev_b32 v174, 16, v187
    v_and_b32 v175, s36, v187
    v_lshlrev_b32 v176, 16, v188
    v_and_b32 v177, s36, v188
    v_lshlrev_b32 v178, 16, v189
    v_and_b32 v179, s36, v189
    v_lshlrev_b32 v180, 16, v190
    v_and_b32 v181, s36, v190
    v_lshlrev_b32 v182, 16, v191
    v_and_b32 v183, s36, v191
    v_lshlrev_b32 v184, 16, v192
    v_and_b32 v185, s36, v192
    v_lshlrev_b32 v186, 16, v193
    v_and_b32 v187, s36, v193
    v_lshlrev_b32 v188, 16, v194
    v_and_b32 v189, s36, v194
    v_lshlrev_b32 v190, 16, v195
    v_and_b32 v191, s36, v195
    v_lshlrev_b32 v192, 16, v196
    v_and_b32 v193, s36, v196
    v_lshlrev_b32 v194, 16, v197
    v_and_b32 v195, s36, v197
    v_lshlrev_b32 v196, 16, v198
    v_and_b32 v197, s36, v198
    v_lshlrev_b32 v198, 16, v199
    v_and_b32 v199, s36, v199
    v_lshlrev_b32 v48, 16, v48
    v_lshlrev_b32 v50, 16, v50
    v_mov_b32 v12, 0xc0135761
    v_mov_b32 v14, 0xbdd2d3e8
    s_lshl_b32 s6, s3, 4
    s_add_u32 s6, s6, 4160
    v_mov_b32 v7, s6
    s_mov_b32 s7, 0
L_bloop:
    v_mov_b32 v16, 0
    v_pk_mul_f32 v[18:19], v[144:145], v[8:9] op_sel_hi:[1,0]
    v_pk_mul_f32 v[24:25], v[146:147], v[8:9] op_sel_hi:[1,0]
    v_cvt_pk_bf16_f32 v22, v18, v19
    v_cvt_pk_bf16_f32 v28, v24, v25
    v_lshlrev_b32 v18, 16, v22
    v_lshlrev_b32 v24, 16, v28
    v_and_b32 v19, s36, v22
    v_and_b32 v25, s36, v28
    v_pk_add_f32 v[18:19], v[18:19], v[172:173]
    v_pk_add_f32 v[24:25], v[24:25], v[174:175]
    v_cvt_pk_bf16_f32 v22, v18, v19
    v_cvt_pk_bf16_f32 v28, v24, v25
    v_lshlrev_b32 v18, 16, v22
    v_lshlrev_b32 v24, 16, v28
    v_and_b32 v19, s36, v22
    v_and_b32 v25, s36, v28
    v_pk_mul_f32 v[20:21], v[18:19], v[18:19]
    v_pk_mul_f32 v[26:27], v[24:25], v[24:25]
    v_pk_fma_f32 v[20:21], v[20:21], v[14:15], v[12:13] op_sel_hi:[1,0,0]
    v_pk_fma_f32 v[26:27], v[26:27], v[14:15], v[12:13] op_sel_hi:[1,0,0]
    v_pk_mul_f32 v[20:21], v[20:21], v[18:19]
    v_pk_mul_f32 v[26:27], v[26:27], v[24:25]
    v_exp_f32 v20, v20
    v_exp_f32 v26, v26
    v_exp_f32 v21, v21
    v_exp_f32 v27, v27
    v_pk_add_f32 v[20:21], v[20:21], 1.0 op_sel_hi:[1,0]
    v_pk_add_f32 v[26:27], v[26:27], 1.0 op_sel_hi:[1,0]
    v_rcp_f32 v20, v20
    v_rcp_f32 v26, v26
    v_rcp_f32 v21, v21
    v_rcp_f32 v27, v27
    v_pk_mul_f32 v[20:21], v[20:21], v[18:19]
    v_pk_mul_f32 v[26:27], v[26:27], v[24:25]
    v_cvt_pk_bf16_f32 v22, v20, v21
    v_cvt_pk_bf16_f32 v28, v26, v27
    v_dot2c_f32_bf16 v16, v22, v200
    v_dot2c_f32_bf16 v16, v28, v201
    v_pk_mul_f32 v[18:19], v[148:149], v[8:9] op_sel_hi:[1,0]
    v_pk_mul_f32 v[24:25], v[150:151], v[8:9] op_sel_hi:[1,0]
    v_cvt_pk_bf16_f32 v22, v18, v19
    v_cvt_pk_bf16_f32 v28, v24, v25
    v_lshlrev_b32 v18, 16, v22
    v_lshlrev_b32 v24, 16, v28
    v_and_b32 v19, s36, v22
    v_and_b32 v25, s36, v28
    v_pk_add_f32 v[18:19], v[18:19], v[176:177]
    v_pk_add_f32 v[24:25], v[24:25], v[178:179]
    v_cvt_pk_bf16_f32 v22, v18, v19
    v_cvt_pk_bf16_f32 v28, v24, v25
    v_lshlrev_b32 v18, 16, v22
    v_lshlrev_b32 v24, 16, v28
    v_and_b32 v19, s36, v22
    v_and_b32 v25, s36, v28
    v_pk_mul_f32 v[20:21], v[18:19], v[18:19]
    v_pk_mul_f32 v[26:27], v[24:25], v[24:25]
    v_pk_fma_f32 v[20:21], v[20:21], v[14:15], v[12:13] op_sel_hi:[1,0,0]
    v_pk_fma_f32 v[26:27], v[26:27], v[14:15], v[12:13] op_sel_hi:[1,0,0]
    v_pk_mul_f32 v[20:21], v[20:21], v[18:19]
    v_pk_mul_f32 v[26:27], v[26:27], v[24:25]
    v_exp_f32 v20, v20
    v_exp_f32 v26, v26
    v_exp_f32 v21, v21
    v_exp_f32 v27, v27
    v_pk_add_f32 v[20:21], v[20:21], 1.0 op_sel_hi:[1,0]
    v_pk_add_f32 v[26:27], v[26:27], 1.0 op_sel_hi:[1,0]
    v_rcp_f32 v20, v20
    v_rcp_f32 v26, v26
    v_rcp_f32 v21, v21
    v_rcp_f32 v27, v27
    v_pk_mul_f32 v[20:21], v[20:21], v[18:19]
    v_pk_mul_f32 v[26:27], v[26:27], v[24:25]
    v_cvt_pk_bf16_f32 v22, v20, v21
    v_cvt_pk_bf16_f32 v28, v26, v27
    v_dot2c_f32_bf16 v16, v22, v202
    v_dot2c_f32_bf16 v16, v28, v203
    v_pk_mul_f32 v[18:19], v[152:153], v[8:9] op_sel_hi:[1,0]
    v_pk_mul_f32 v[24:25], v[154:155], v[8:9] op_sel_hi:[1,0]
    v_cvt_pk_bf16_f32 v22, v18, v19
    v_cvt_pk_bf16_f32 v28, v24, v25
    v_lshlrev_b32 v18, 16, v22
    v_lshlrev_b32 v24, 16, v28
    v_and_b32 v19, s36, v22
    v_and_b32 v25, s36, v28
    v_pk_add_f32 v[18:19], v[18:19], v[180:181]
    v_pk_add_f32 v[24:25], v[24:25], v[182:183]
    v_cvt_pk_bf16_f32 v22, v18, v19
    v_cvt_pk_bf16_f32 v28, v24, v25
    v_lshlrev_b32 v18, 16, v22
    v_lshlrev_b32 v24, 16, v28
    v_and_b32 v19, s36, v22
    v_and_b32 v25, s36, v28
    v_pk_mul_f32 v[20:21], v[18:19], v[18:19]
    v_pk_mul_f32 v[26:27], v[24:25], v[24:25]
    v_pk_fma_f32 v[20:21], v[20:21], v[14:15], v[12:13] op_sel_hi:[1,0,0]
    v_pk_fma_f32 v[26:27], v[26:27], v[14:15], v[12:13] op_sel_hi:[1,0,0]
    v_pk_mul_f32 v[20:21], v[20:21], v[18:19]
    v_pk_mul_f32 v[26:27], v[26:27], v[24:25]
    v_exp_f32 v20, v20
    v_exp_f32 v26, v26
    v_exp_f32 v21, v21
    v_exp_f32 v27, v27
    v_pk_add_f32 v[20:21], v[20:21], 1.0 op_sel_hi:[1,0]
    v_pk_add_f32 v[26:27], v[26:27], 1.0 op_sel_hi:[1,0]
    v_rcp_f32 v20, v20
    v_rcp_f32 v26, v26
    v_rcp_f32 v21, v21
    v_rcp_f32 v27, v27
    v_pk_mul_f32 v[20:21], v[20:21], v[18:19]
    v_pk_mul_f32 v[26:27], v[26:27], v[24:25]
    v_cvt_pk_bf16_f32 v22, v20, v21
    v_cvt_pk_bf16_f32 v28, v26, v27
    v_dot2c_f32_bf16 v16, v22, v204
    v_dot2c_f32_bf16 v16, v28, v205
    v_pk_mul_f32 v[18:19], v[156:157], v[8:9] op_sel_hi:[1,0]
    v_pk_mul_f32 v[24:25], v[158:159], v[8:9] op_sel_hi:[1,0]
    v_cvt_pk_bf16_f32 v22, v18, v19
    v_cvt_pk_bf16_f32 v28, v24, v25
    v_lshlrev_b32 v18, 16, v22
    v_lshlrev_b32 v24, 16, v28
    v_and_b32 v19, s36, v22
    v_and_b32 v25, s36, v28
    v_pk_add_f32 v[18:19], v[18:19], v[184:185]
    v_pk_add_f32 v[24:25], v[24:25], v[186:187]
    v_cvt_pk_bf16_f32 v22, v18, v19
    v_cvt_pk_bf16_f32 v28, v24, v25
    v_lshlrev_b32 v18, 16, v22
    v_lshlrev_b32 v24, 16, v28
    v_and_b32 v19, s36, v22
    v_and_b32 v25, s36, v28
    v_pk_mul_f32 v[20:21], v[18:19], v[18:19]
    v_pk_mul_f32 v[26:27], v[24:25], v[24:25]
    v_pk_fma_f32 v[20:21], v[20:21], v[14:15], v[12:13] op_sel_hi:[1,0,0]
    v_pk_fma_f32 v[26:27], v[26:27], v[14:15], v[12:13] op_sel_hi:[1,0,0]
    v_pk_mul_f32 v[20:21], v[20:21], v[18:19]
    v_pk_mul_f32 v[26:27], v[26:27], v[24:25]
    v_exp_f32 v20, v20
    v_exp_f32 v26, v26
    v_exp_f32 v21, v21
    v_exp_f32 v27, v27
    v_pk_add_f32 v[20:21], v[20:21], 1.0 op_sel_hi:[1,0]
    v_pk_add_f32 v[26:27], v[26:27], 1.0 op_sel_hi:[1,0]
    v_rcp_f32 v20, v20
    v_rcp_f32 v26, v26
    v_rcp_f32 v21, v21
    v_rcp_f32 v27, v27
    v_pk_mul_f32 v[20:21], v[20:21], v[18:19]
    v_pk_mul_f32 v[26:27], v[26:27], v[24:25]
    v_cvt_pk_bf16_f32 v22, v20, v21
    v_cvt_pk_bf16_f32 v28, v26, v27
    v_dot2c_f32_bf16 v16, v22, v206
    v_dot2c_f32_bf16 v16, v28, v207
    v_pk_mul_f32 v[18:19], v[160:161], v[8:9] op_sel_hi:[1,0]
    v_pk_mul_f32 v[24:25], v[162:163], v[8:9] op_sel_hi:[1,0]
    v_cvt_pk_bf16_f32 v22, v18, v19
    v_cvt_pk_bf16_f32 v28, v24, v25
    v_lshlrev_b32 v18, 16, v22
    v_lshlrev_b32 v24, 16, v28
    v_and_b32 v19, s36, v22
    v_and_b32 v25, s36, v28
    v_pk_add_f32 v[18:19], v[18:19], v[188:189]
    v_pk_add_f32 v[24:25], v[24:25], v[190:191]
    v_cvt_pk_bf16_f32 v22, v18, v19
    v_cvt_pk_bf16_f32 v28, v24, v25
    v_lshlrev_b32 v18, 16, v22
    v_lshlrev_b32 v24, 16, v28
    v_and_b32 v19, s36, v22
    v_and_b32 v25, s36, v28
    v_pk_mul_f32 v[20:21], v[18:19], v[18:19]
    v_pk_mul_f32 v[26:27], v[24:25], v[24:25]
    v_pk_fma_f32 v[20:21], v[20:21], v[14:15], v[12:13] op_sel_hi:[1,0,0]
    v_pk_fma_f32 v[26:27], v[26:27], v[14:15], v[12:13] op_sel_hi:[1,0,0]
    v_pk_mul_f32 v[20:21], v[20:21], v[18:19]
    v_pk_mul_f32 v[26:27], v[26:27], v[24:25]
    v_exp_f32 v20, v20
    v_exp_f32 v26, v26
    v_exp_f32 v21, v21
    v_exp_f32 v27, v27
    v_pk_add_f32 v[20:21], v[20:21], 1.0 op_sel_hi:[1,0]
    v_pk_add_f32 v[26:27], v[26:27], 1.0 op_sel_hi:[1,0]
    v_rcp_f32 v20, v20
    v_rcp_f32 v26, v26
    v_rcp_f32 v21, v21
    v_rcp_f32 v27, v27
    v_pk_mul_f32 v[20:21], v[20:21], v[18:19]
    v_pk_mul_f32 v[26:27], v[26:27], v[24:25]
    v_cvt_pk_bf16_f32 v22, v20, v21
    v_cvt_pk_bf16_f32 v28, v26, v27
    v_dot2c_f32_bf16 v16, v22, v208
    v_dot2c_f32_bf16 v16, v28, v209
    v_pk_mul_f32 v[18:19], v[164:165], v[8:9] op_sel_hi:[1,0]
    v_pk_mul_f32 v[24:25], v[166:167], v[8:9] op_sel_hi:[1,0]
    v_cvt_pk_bf16_f32 v22, v18, v19
    v_cvt_pk_bf16_f32 v28, v24, v25
    v_lshlrev_b32 v18, 16, v22
    v_lshlrev_b32 v24, 16, v28
    v_and_b32 v19, s36, v22
    v_and_b32 v25, s36, v28
    v_pk_add_f32 v[18:19], v[18:19], v[192:193]
    v_pk_add_f32 v[24:25], v[24:25], v[194:195]
    v_cvt_pk_bf16_f32 v22, v18, v19
    v_cvt_pk_bf16_f32 v28, v24, v25
    v_lshlrev_b32 v18, 16, v22
    v_lshlrev_b32 v24, 16, v28
    v_and_b32 v19, s36, v22
    v_and_b32 v25, s36, v28
    v_pk_mul_f32 v[20:21], v[18:19], v[18:19]
    v_pk_mul_f32 v[26:27], v[24:25], v[24:25]
    v_pk_fma_f32 v[20:21], v[20:21], v[14:15], v[12:13] op_sel_hi:[1,0,0]
    v_pk_fma_f32 v[26:27], v[26:27], v[14:15], v[12:13] op_sel_hi:[1,0,0]
    v_pk_mul_f32 v[20:21], v[20:21], v[18:19]
    v_pk_mul_f32 v[26:27], v[26:27], v[24:25]
    v_exp_f32 v20, v20
    v_exp_f32 v26, v26
    v_exp_f32 v21, v21
    v_exp_f32 v27, v27
    v_pk_add_f32 v[20:21], v[20:21], 1.0 op_sel_hi:[1,0]
    v_pk_add_f32 v[26:27], v[26:27], 1.0 op_sel_hi:[1,0]
    v_rcp_f32 v20, v20
    v_rcp_f32 v26, v26
    v_rcp_f32 v21, v21
    v_rcp_f32 v27, v27
    v_pk_mul_f32 v[20:21], v[20:21], v[18:19]
    v_pk_mul_f32 v[26:27], v[26:27], v[24:25]
    v_cvt_pk_bf16_f32 v22, v20, v21
    v_cvt_pk_bf16_f32 v28, v26, v27
    v_dot2c_f32_bf16 v16, v22, v210
    v_dot2c_f32_bf16 v16, v28, v211
    v_pk_mul_f32 v[18:19], v[168:169], v[8:9] op_sel_hi:[1,0]
    v_pk_mul_f32 v[24:25], v[170:171], v[8:9] op_sel_hi:[1,0]
    v_cvt_pk_bf16_f32 v22, v18, v19
    v_cvt_pk_bf16_f32 v28, v24, v25
    v_lshlrev_b32 v18, 16, v22
    v_lshlrev_b32 v24, 16, v28
    v_and_b32 v19, s36, v22
    v_and_b32 v25, s36, v28
    v_pk_add_f32 v[18:19], v[18:19], v[196:197]
    v_pk_add_f32 v[24:25], v[24:25], v[198:199]
    v_cvt_pk_bf16_f32 v22, v18, v19
    v_cvt_pk_bf16_f32 v28, v24, v25
    v_lshlrev_b32 v18, 16, v22
    v_lshlrev_b32 v24, 16, v28
    v_and_b32 v19, s36, v22
    v_and_b32 v25, s36, v28
    v_pk_mul_f32 v[20:21], v[18:19], v[18:19]
    v_pk_mul_f32 v[26:27], v[24:25], v[24:25]
    v_pk_fma_f32 v[20:21], v[20:21], v[14:15], v[12:13] op_sel_hi:[1,0,0]
    v_pk_fma_f32 v[26:27], v[26:27], v[14:15], v[12:13] op_sel_hi:[1,0,0]
    v_pk_mul_f32 v[20:21], v[20:21], v[18:19]
    v_pk_mul_f32 v[26:27], v[26:27], v[24:25]
    v_exp_f32 v20, v20
    v_exp_f32 v26, v26
    v_exp_f32 v21, v21
    v_exp_f32 v27, v27
    v_pk_add_f32 v[20:21], v[20:21], 1.0 op_sel_hi:[1,0]
    v_pk_add_f32 v[26:27], v[26:27], 1.0 op_sel_hi:[1,0]
    v_rcp_f32 v20, v20
    v_rcp_f32 v26, v26
    v_rcp_f32 v21, v21
    v_rcp_f32 v27, v27
    v_pk_mul_f32 v[20:21], v[20:21], v[18:19]
    v_pk_mul_f32 v[26:27], v[26:27], v[24:25]
    v_cvt_pk_bf16_f32 v22, v20, v21
    v_cvt_pk_bf16_f32 v28, v26, v27
    v_dot2c_f32_bf16 v16, v22, v212
    v_dot2c_f32_bf16 v16, v28, v213
    s_nop 2
    v_add_f32_dpp v16, v16, v16 row_ror:8 row_mask:0xf bank_mask:0xf
    s_nop 1
    v_add_f32_dpp v16, v16, v16 row_ror:4 row_mask:0xf bank_mask:0xf
    s_nop 1
    v_add_f32_dpp v16, v16, v16 row_ror:2 row_mask:0xf bank_mask:0xf
    s_nop 1
    v_add_f32_dpp v16, v16, v16 row_ror:1 row_mask:0xf bank_mask:0xf
    v_mov_b32 v17, v16
    s_nop 1
    v_permlane16_swap_b32 v16, v17
    v_add_f32 v16, v16, v17
    v_mov_b32 v17, v16
    s_nop 1
    v_permlane32_swap_b32 v16, v17
    v_add_f32 v16, v16, v17
    v_cvt_pk_bf16_f32 v16, v16, v16
    v_and_b32 v16, s36, v16
    v_add_f32 v16, v16, v48
    v_cvt_pk_bf16_f32 v16, v16, v16
    v_and_b32 v16, s36, v16
    ds_write_b32 v7, v16
    v_add_u32 v7, 4, v7
    v_mov_b32 v8, v9
    v_mov_b32 v9, v10
    v_mov_b32 v10, v11
    s_call_b64 s[56:57], L_step
    s_add_u32 s7, s7, 1
    s_cmp_lt_u32 s7, 4
    s_cbranch_scc1 L_bloop
    s_add_u32 s91, s91, 4096
    s_and_b32 s91, s91, 0x7fff
    buffer_load_dwordx4 v[144:147], v0, s[92:95], s91 offen
    s_waitcnt vmcnt(0)
    s_cmp_lg_u32 s3, 2
    s_cbranch_scc1 L_ns1
    s_call_b64 s[84:85], L_svc
L_ns1:
    buffer_load_dwordx4 v[148:151], v0, s[92:95], s91 offen offset:1024
    s_waitcnt vmcnt(0)
    s_cmp_lg_u32 s3, 2
    s_cbranch_scc1 L_ns2
    s_call_b64 s[84:85], L_svc
L_ns2:
    buffer_load_dwordx4 v[152:155], v0, s[92:95], s91 offen offset:2048
    s_waitcnt vmcnt(0)
    s_cmp_lg_u32 s3, 2
    s_cbranch_scc1 L_ns3
    s_call_b64 s[84:85], L_svc
L_ns3:
    buffer_load_dwordx4 v[156:159], v0, s[92:95], s91 offen offset:3072
    s_call_b64 s[56:57], L_step
    s_lshr_b32 s6, s2, 3
    s_and_b32 s83, s96, 3
    s_add_u32 s6, s6, s83
    s_and_b32 s6, s6, 3
    s_lshl_b32 s6, s6, 2
    s_or_b32 s6, s6, s3
    s_cmp_lg_u32 s6, 2
    s_cbranch_scc1 L_nox0
    s_mov_b32 s7, 0
    s_and_b32 s6, s30, 4
    s_load_dword s87, s[26:27], s6
    s_waitcnt lgkmcnt(0)
L_fwx:
    s_and_b32 s6, s30, 3
    s_lshl_b32 s6, s6, 3
    s_lshr_b32 s87, s87, s6
    s_bitcmp1_b32 s87, 0
    s_cbranch_scc1 L_fox
    s_sleep 8
    v_mov_b32 v53, 8
    s_mov_b64 exec, 1
    global_load_dword v52, v6, s[26:27] offset:0 sc1
    s_mov_b64 exec, -1
    s_waitcnt vmcnt(0)
    v_readfirstlane_b32 s87, v52
    s_add_u32 s7, s7, 1
    s_cmp_lt_u32 s7, 0x400000
    s_cbranch_scc1 L_fwx
L_fox:
    s_lshr_b32 s6, s87, 2
    s_add_u32 s6, s6, s96
    s_lshr_b32 s6, s6, 1
    s_xor_b32 s6, s6, s2
    s_xor_b32 s6, s6, s87
    s_lshr_b32 s6, s6, 1
    s_xor_b32 s6, s6, 1
    s_and_b32 s6, s6, 1
    s_or_b32 s6, s6, 2
    v_mov_b32 v52, s6
    ds_write_b32 v56, v52 offset:244
L_nox0:
    s_add_u32 s91, s91, 4096
    s_and_b32 s91, s91, 0x7fff
    buffer_load_dwordx4 v[160:163], v0, s[92:95], s91 offen
    s_waitcnt vmcnt(0)
    s_cmp_lg_u32 s3, 2
    s_cbranch_scc1 L_ns4
    s_call_b64 s[84:85], L_svc
L_ns4:
    buffer_load_dwordx4 v[164:167], v0, s[92:95], s91 offen offset:1024
    s_waitcnt vmcnt(0)
    s_cmp_lg_u32 s3, 2
    s_cbranch_scc1 L_ns5
    s_call_b64 s[84:85], L_svc
L_ns5:
    buffer_load_dwordx4 v[168:171], v0, s[92:95], s91 offen offset:2048
    s_waitcnt vmcnt(0)
    s_cmp_lg_u32 s3, 2
    s_cbranch_scc1 L_ns6
    s_call_b64 s[84:85], L_svc
L_ns6:
    buffer_load_dwordx4 v[172:175], v0, s[92:95], s91 offen offset:3072
    s_call_b64 s[56:57], L_step
    s_add_u32 s91, s91, 4096
    s_and_b32 s91, s91, 0x7fff
    buffer_load_dwordx4 v[176:179], v0, s[92:95], s91 offen
    s_waitcnt vmcnt(0)
    s_cmp_lg_u32 s3, 2
    s_cbranch_scc1 L_ns7
    s_call_b64 s[84:85], L_svc
L_ns7:
    buffer_load_dwordx4 v[180:183], v0, s[92:95], s91 offen offset:1024
    s_waitcnt vmcnt(0)
    s_cmp_lg_u32 s3, 2
    s_cbranch_scc1 L_ns8
    s_call_b64 s[84:85], L_svc
L_ns8:
    buffer_load_dwordx4 v[184:187], v0, s[92:95], s91 offen offset:2048
    s_waitcnt vmcnt(0)
    s_cmp_lg_u32 s3, 2
    s_cbranch_scc1 L_ns9
    s_call_b64 s[84:85], L_svc
L_ns9:
    buffer_load_dwordx4 v[188:191], v0, s[92:95], s91 offen offset:3072
    s_call_b64 s[56:57], L_step
    s_add_u32 s91, s91, 4096
    s_and_b32 s91, s91, 0x7fff
    buffer_load_dwordx4 v[192:195], v0, s[92:95], s91 offen
    s_waitcnt vmcnt(0)
    s_cmp_lg_u32 s3, 2
    s_cbranch_scc1 L_ns10
    s_call_b64 s[84:85], L_svc
L_ns10:
    buffer_load_dwordx4 v[196:199], v0, s[92:95], s91 offen offset:1024
    s_waitcnt vmcnt(0)
    s_cmp_lg_u32 s3, 2
    s_cbranch_scc1 L_ns11
    s_call_b64 s[84:85], L_svc
L_ns11:
    buffer_load_dwordx4 v[200:203], v0, s[92:95], s91 offen offset:2048
    s_waitcnt vmcnt(0)
    s_cmp_lg_u32 s3, 2
    s_cbranch_scc1 L_ns12
    s_call_b64 s[84:85], L_svc
L_ns12:
    buffer_load_dwordx4 v[204:207], v0, s[92:95], s91 offen offset:3072
    s_call_b64 s[56:57], L_step
    s_add_u32 s91, s91, 4096
    s_and_b32 s91, s91, 0x7fff
    buffer_load_dwordx4 v[208:211], v0, s[92:95], s91 offen
    s_waitcnt vmcnt(0)
    s_cmp_lg_u32 s3, 2
    s_cbranch_scc1 L_ns13
    s_call_b64 s[84:85], L_svc
L_ns13:
    buffer_load_dwordx4 v[212:215], v0, s[92:95], s91 offen offset:1024
    s_waitcnt vmcnt(0)
    s_cmp_lg_u32 s3, 2
    s_cbranch_scc1 L_ns14
    s_call_b64 s[84:85], L_svc
L_ns14:
    buffer_load_dwordx4 v[216:219], v0, s[92:95], s91 offen offset:2048
    s_waitcnt vmcnt(0)
    s_cmp_lg_u32 s3, 2
    s_cbranch_scc1 L_ns15
    s_call_b64 s[84:85], L_svc
L_ns15:
    buffer_load_dwordx4 v[220:223], v0, s[92:95], s91 offen offset:3072
    s_call_b64 s[56:57], L_step
    s_add_u32 s91, s91, 4096
    s_and_b32 s91, s91, 0x7fff
    buffer_load_dwordx4 v[224:227], v0, s[92:95], s91 offen
    s_waitcnt vmcnt(0)
    s_cmp_lg_u32 s3, 2
    s_cbranch_scc1 L_ns16
    s_call_b64 s[84:85], L_svc
L_ns16:
    buffer_load_dwordx4 v[228:231], v0, s[92:95], s91 offen offset:1024
    s_waitcnt vmcnt(0)
    s_cmp_lg_u32 s3, 2
    s_cbranch_scc1 L_ns17
    s_call_b64 s[84:85], L_svc
L_ns17:
    buffer_load_dwordx4 v[232:235], v0, s[92:95], s91 offen offset:2048
    s_waitcnt vmcnt(0)
    s_cmp_lg_u32 s3, 2
    s_cbranch_scc1 L_ns18
    s_call_b64 s[84:85], L_svc
L_ns18:
    buffer_load_dwordx4 v[236:239], v0, s[92:95], s91 offen offset:3072
    s_call_b64 s[56:57], L_step
    s_add_u32 s91, s91, 4096
    s_and_b32 s91, s91, 0x7fff
    buffer_load_dwordx4 v[240:243], v0, s[92:95], s91 offen
    s_waitcnt vmcnt(0)
    s_cmp_lg_u32 s3, 2
    s_cbranch_scc1 L_ns19
    s_call_b64 s[84:85], L_svc
L_ns19:
    buffer_load_dwordx4 v[244:247], v0, s[92:95], s91 offen offset:1024
    s_waitcnt vmcnt(0)
    s_cmp_lg_u32 s3, 2
    s_cbranch_scc1 L_ns20
    s_call_b64 s[84:85], L_svc
L_ns20:
    buffer_load_dwordx4 v[248:251], v0, s[92:95], s91 offen offset:2048
    s_waitcnt vmcnt(0)
    s_cmp_lg_u32 s3, 2
    s_cbranch_scc1 L_ns21
    s_call_b64 s[84:85], L_svc
L_ns21:
    buffer_load_dwordx4 v[252:255], v0, s[92:95], s91 offen offset:3072
    s_call_b64 s[56:57], L_step
    s_mov_b32 s7, 0
    s_and_b32 s6, s30, 4
    s_load_dword s87, s[26:27], s6
    s_load_dword s88, s[26:27], 8
    s_waitcnt lgkmcnt(0)
L_fwc:
    s_and_b32 s6, s30, 3
    s_lshl_b32 s6, s6, 3
    s_lshr_b32 s87, s87, s6
    s_and_b32 s6, s87, s88
    s_bitcmp1_b32 s6, 0
    s_cbranch_scc1 L_foc
    s_sleep 8
    v_mov_b32 v53, 8
    s_mov_b64 exec, 1
    global_load_dword v52, v6, s[26:27] offset:0 sc1
    global_load_dword v53, v53, s[26:27] sc1
    s_mov_b64 exec, -1
    s_waitcnt vmcnt(0)
    v_readfirstlane_b32 s87, v52
    v_readfirstlane_b32 s88, v53
    s_add_u32 s7, s7, 1
    s_cmp_lt_u32 s7, 0x400000
    s_cbranch_scc1 L_fwc
L_foc:
    s_waitcnt vmcnt(0)
    v_perm_b32 v96, v132, v128, s39
    v_perm_b32 v100, v132, v128, s40
    v_perm_b32 v104, v133, v129, s39
    v_perm_b32 v108, v133, v129, s40
    v_perm_b32 v112, v134, v130, s39
    v_perm_b32 v116, v134, v130, s40
    v_perm_b32 v120, v135, v131, s39
    v_perm_b32 v124, v135, v131, s40
    v_perm_b32 v97, v140, v136, s39
    v_perm_b32 v101, v140, v136, s40
    v_perm_b32 v105, v141, v137, s39
    v_perm_b32 v109, v141, v137, s40
    v_perm_b32 v113, v142, v138, s39
    v_perm_b32 v117, v142, v138, s40
    v_perm_b32 v121, v143, v139, s39
    v_perm_b32 v125, v143, v139, s40
    v_perm_b32 v98, v148, v144, s39
    v_perm_b32 v102, v148, v144, s40
    v_perm_b32 v106, v149, v145, s39
    v_perm_b32 v110, v149, v145, s40
    v_perm_b32 v114, v150, v146, s39
    v_perm_b32 v118, v150, v146, s40
    v_perm_b32 v122, v151, v147, s39
    v_perm_b32 v126, v151, v147, s40
    v_perm_b32 v99, v156, v152, s39
    v_perm_b32 v103, v156, v152, s40
    v_perm_b32 v107, v157, v153, s39
    v_perm_b32 v111, v157, v153, s40
    v_perm_b32 v115, v158, v154, s39
    v_perm_b32 v119, v158, v154, s40
    v_perm_b32 v123, v159, v155, s39
    v_perm_b32 v127, v159, v155, s40
    v_perm_b32 v128, v164, v160, s39
    v_perm_b32 v132, v164, v160, s40
    v_perm_b32 v136, v165, v161, s39
    v_perm_b32 v140, v165, v161, s40
    v_perm_b32 v144, v166, v162, s39
    v_perm_b32 v148, v166, v162, s40
    v_perm_b32 v152, v167, v163, s39
    v_perm_b32 v156, v167, v163, s40
    v_perm_b32 v129, v172, v168, s39
    v_perm_b32 v133, v172, v168, s40
    v_perm_b32 v137, v173, v169, s39
    v_perm_b32 v141, v173, v169, s40
    v_perm_b32 v145, v174, v170, s39
    v_perm_b32 v149, v174, v170, s40
    v_perm_b32 v153, v175, v171, s39
    v_perm_b32 v157, v175, v171, s40
    v_perm_b32 v130, v180, v176, s39
    v_perm_b32 v134, v180, v176, s40
    v_perm_b32 v138, v181, v177, s39
    v_perm_b32 v142, v181, v177, s40
    v_perm_b32 v146, v182, v178, s39
    v_perm_b32 v150, v182, v178, s40
    v_perm_b32 v154, v183, v179, s39
    v_perm_b32 v158, v183, v179, s40
    v_perm_b32 v131, v188, v184, s39
    v_perm_b32 v135, v188, v184, s40
    v_perm_b32 v139, v189, v185, s39
    v_perm_b32 v143, v189, v185, s40
    v_perm_b32 v147, v190, v186, s39
    v_perm_b32 v151, v190, v186, s40
    v_perm_b32 v155, v191, v187, s39
    v_perm_b32 v159, v191, v187, s40
    v_perm_b32 v160, v196, v192, s39
    v_perm_b32 v164, v196, v192, s40
    v_perm_b32 v168, v197, v193, s39
    v_perm_b32 v172, v197, v193, s40
    v_perm_b32 v176, v198, v194, s39
    v_perm_b32 v180, v198, v194, s40
    v_perm_b32 v184, v199, v195, s39
    v_perm_b32 v188, v199, v195, s40
    v_perm_b32 v161, v204, v200, s39
    v_perm_b32 v165, v204, v200, s40
    v_perm_b32 v169, v205, v201, s39
    v_perm_b32 v173, v205, v201, s40
    v_perm_b32 v177, v206, v202, s39
    v_perm_b32 v181, v206, v202, s40
    v_perm_b32 v185, v207, v203, s39
    v_perm_b32 v189, v207, v203, s40
    v_perm_b32 v162, v212, v208, s39
    v_perm_b32 v166, v212, v208, s40
    v_perm_b32 v170, v213, v209, s39
    v_perm_b32 v174, v213, v209, s40
    v_perm_b32 v178, v214, v210, s39
    v_perm_b32 v182, v214, v210, s40
    v_perm_b32 v186, v215, v211, s39
    v_perm_b32 v190, v215, v211, s40
    v_perm_b32 v163, v220, v216, s39
    v_perm_b32 v167, v220, v216, s40
    v_perm_b32 v171, v221, v217, s39
    v_perm_b32 v175, v221, v217, s40
    v_perm_b32 v179, v222, v218, s39
    v_perm_b32 v183, v222, v218, s40
    v_perm_b32 v187, v223, v219, s39
    v_perm_b32 v191, v223, v219, s40
    v_perm_b32 v192, v228, v224, s39
    v_perm_b32 v196, v228, v224, s40
    v_perm_b32 v200, v229, v225, s39
    v_perm_b32 v204, v229, v225, s40
    v_perm_b32 v208, v230, v226, s39
    v_perm_b32 v212, v230, v226, s40
    v_perm_b32 v216, v231, v227, s39
    v_perm_b32 v220, v231, v227, s40
    v_perm_b32 v193, v236, v232, s39
    v_perm_b32 v197, v236, v232, s40
    v_perm_b32 v201, v237, v233, s39
    v_perm_b32 v205, v237, v233, s40
    v_perm_b32 v209, v238, v234, s39
    v_perm_b32 v213, v238, v234, s40
    v_perm_b32 v217, v239, v235, s39
    v_perm_b32 v221, v239, v235, s40
    v_perm_b32 v194, v244, v240, s39
    v_perm_b32 v198, v244, v240, s40
    v_perm_b32 v202, v245, v241, s39
    v_perm_b32 v206, v245, v241, s40
    v_perm_b32 v210, v246, v242, s39
    v_perm_b32 v214, v246, v242, s40
    v_perm_b32 v218, v247, v243, s39
    v_perm_b32 v222, v247, v243, s40
    v_perm_b32 v195, v252, v248, s39
    v_perm_b32 v199, v252, v248, s40
    v_perm_b32 v203, v253, v249, s39
    v_perm_b32 v207, v253, v249, s40
    v_perm_b32 v211, v254, v250, s39
    v_perm_b32 v215, v254, v250, s40
    v_perm_b32 v219, v255, v251, s39
    v_perm_b32 v223, v255, v251, s40
    s_lshl_b32 s6, s30, 1
    v_add_u32 v29, s6, v3
    v_and_b32 v29, 15, v29
    v_lshl_add_u32 v29, v2, 4, v29
    v_lshlrev_b32 v29, 3, v29
    s_lshl_b32 s6, s30, 16
    s_lshl_b32 s7, s3, 14
    s_add_u32 s6, s6, s7
    s_lshl_b32 s7, s31, 6
    s_add_u32 s6, s6, s7
    v_lshrrev_b32 v30, 1, v3
    v_lshlrev_b32 v30, 11, v30
    v_and_b32 v4, 1, v3
    v_lshl_add_u32 v30, v4, 5, v30
    v_lshl_add_u32 v30, v2, 2, v30
    v_add_u32 v30, s6, v30
    v_mov_b32 v24, 0
    v_mov_b32 v25, 0
    v_mov_b32 v26, 0
    v_mov_b32 v27, 0
    v_lshl_add_u32 v30, v2, 2, v30
    v_lshl_add_u32 v30, v2, 3, v30
    v_mov_b32 v44, -2
    s_lshr_b32 s89, s88, 2
    s_lshl_b32 s88, s88, 1
    s_add_u32 s6, s89, s96
    s_xor_b32 s6, s6, s2
    s_xor_b32 s6, s6, s88
    s_and_b32 s6, s6, 4
    s_lshl_b32 s6, s6, 11
    v_xor_b32 v39, s6, v39
    v_lshrrev_b32 v16, 1, v3
    v_xor_b32 v16, s3, v16
    v_add_u32 v17, s89, v16
    v_xor_b32 v16, v16, v17
    v_xor_b32 v16, s88, v16
    v_and_b32 v16, 4, v16
    v_lshlrev_b32 v16, 11, v16
    v_xor_b32 v30, v16, v30
    s_mov_b32 s48, s24
    s_mov_b32 s49, s25
    s_mov_b32 s50, 8192
    s_call_b64 s[56:57], L_step
    s_mov_b32 s17, 1
    s_mov_b32 s7, 0
    v_xor_b32 v30, 2.0, v30
    v_xor_b32 v39, 2.0, v39
    v_xor_b32 v49, 2.0, v49
    s_branch L_tail
L_real:
    s_mov_b64 exec, -1
    v_xor_b32 v30, 2.0, v30
    v_xor_b32 v39, 2.0, v39
    v_xor_b32 v49, 2.0, v49
    s_waitcnt vmcnt(0)
    s_mov_b32 s17, 0
    s_call_b64 s[56:57], L_step
    s_cmp_lg_u32 s3, 2
    s_cbranch_scc1 L_xdone
L_xfin:
    s_call_b64 s[84:85], L_svc
    s_cmp_lt_u32 s80, 4
    s_cbranch_scc1 L_xfin
L_xdone:
    s_mov_b32 s7, 0
    s_setprio 3
    s_waitcnt lgkmcnt(0)
    s_barrier
L_tail:
    ds_read_b64 v[8:9], v29 offset:2048
    ds_read_b64 v[10:11], v29 offset:2560
    ds_read_b64 v[12:13], v29 offset:3072
    ds_read_b64 v[14:15], v29 offset:3584
    ds_read_b64 v[16:17], v29 offset:9728
    s_waitcnt lgkmcnt(3)
    v_pk_add_f32 v[8:9], v[8:9], v[10:11]
    s_waitcnt lgkmcnt(1)
    v_pk_add_f32 v[12:13], v[12:13], v[14:15]
    s_waitcnt lgkmcnt(0)
    v_pk_add_f32 v[8:9], v[8:9], v[16:17]
    v_pk_add_f32 v[8:9], v[8:9], v[12:13]
    v_cvt_pk_bf16_f32 v28, v8, v9
    s_nop 1
    v_mov_b32_dpp v80, v28 row_newbcast:0 row_mask:0xf bank_mask:0xf
    v_mov_b32_dpp v81, v28 row_newbcast:1 row_mask:0xf bank_mask:0xf
    v_mov_b32_dpp v82, v28 row_newbcast:2 row_mask:0xf bank_mask:0xf
    v_mov_b32_dpp v83, v28 row_newbcast:3 row_mask:0xf bank_mask:0xf
    s_nop 1
    v_mfma_f32_16x16x32_bf16 v[224:227], v[80:83], v[96:99], 0
    v_mov_b32_dpp v84, v28 row_newbcast:4 row_mask:0xf bank_mask:0xf
    v_mfma_f32_16x16x32_bf16 v[228:231], v[80:83], v[100:103], 0
    v_mov_b32_dpp v85, v28 row_newbcast:5 row_mask:0xf bank_mask:0xf
    v_mfma_f32_16x16x32_bf16 v[232:235], v[80:83], v[104:107], 0
    v_mov_b32_dpp v86, v28 row_newbcast:6 row_mask:0xf bank_mask:0xf
    v_mfma_f32_16x16x32_bf16 v[236:239], v[80:83], v[108:111], 0
    v_mov_b32_dpp v87, v28 row_newbcast:7 row_mask:0xf bank_mask:0xf
    v_mfma_f32_16x16x32_bf16 v[240:243], v[80:83], v[112:115], 0
    v_mfma_f32_16x16x32_bf16 v[244:247], v[80:83], v[116:119], 0
    v_mfma_f32_16x16x32_bf16 v[248:251], v[80:83], v[120:123], 0
    v_mfma_f32_16x16x32_bf16 v[252:255], v[80:83], v[124:127], 0
    v_mfma_f32_16x16x32_bf16 v[224:227], v[84:87], v[128:131], v[224:227]
    v_mov_b32_dpp v88, v28 row_newbcast:8 row_mask:0xf bank_mask:0xf
    v_mfma_f32_16x16x32_bf16 v[228:231], v[84:87], v[132:135], v[228:231]
    v_mov_b32_dpp v89, v28 row_newbcast:9 row_mask:0xf bank_mask:0xf
    v_mfma_f32_16x16x32_bf16 v[232:235], v[84:87], v[136:139], v[232:235]
    v_mov_b32_dpp v90, v28 row_newbcast:10 row_mask:0xf bank_mask:0xf
    v_mfma_f32_16x16x32_bf16 v[236:239], v[84:87], v[140:143], v[236:239]
    v_mov_b32_dpp v91, v28 row_newbcast:11 row_mask:0xf bank_mask:0xf
    v_mfma_f32_16x16x32_bf16 v[240:243], v[84:87], v[144:147], v[240:243]
    v_mfma_f32_16x16x32_bf16 v[244:247], v[84:87], v[148:151], v[244:247]
    v_mfma_f32_16x16x32_bf16 v[248:251], v[84:87], v[152:155], v[248:251]
    v_mfma_f32_16x16x32_bf16 v[252:255], v[84:87], v[156:159], v[252:255]
    v_mfma_f32_16x16x32_bf16 v[224:227], v[88:91], v[160:163], v[224:227]
    v_mov_b32_dpp v92, v28 row_newbcast:12 row_mask:0xf bank_mask:0xf
    v_mfma_f32_16x16x32_bf16 v[228:231], v[88:91], v[164:167], v[228:231]
    v_mov_b32_dpp v93, v28 row_newbcast:13 row_mask:0xf bank_mask:0xf
    v_mfma_f32_16x16x32_bf16 v[232:235], v[88:91], v[168:171], v[232:235]
    v_mov_b32_dpp v94, v28 row_newbcast:14 row_mask:0xf bank_mask:0xf
    v_mfma_f32_16x16x32_bf16 v[236:239], v[88:91], v[172:175], v[236:239]
    v_mov_b32_dpp v95, v28 row_newbcast:15 row_mask:0xf bank_mask:0xf
    v_mfma_f32_16x16x32_bf16 v[240:243], v[88:91], v[176:179], v[240:243]
    v_mfma_f32_16x16x32_bf16 v[244:247], v[88:91], v[180:183], v[244:247]
    v_mfma_f32_16x16x32_bf16 v[248:251], v[88:91], v[184:187], v[248:251]
    v_mfma_f32_16x16x32_bf16 v[252:255], v[88:91], v[188:191], v[252:255]
    v_mfma_f32_16x16x32_bf16 v[224:227], v[92:95], v[192:195], v[224:227]
    v_mfma_f32_16x16x32_bf16 v[228:231], v[92:95], v[196:199], v[228:231]
    v_mfma_f32_16x16x32_bf16 v[232:235], v[92:95], v[200:203], v[232:235]
    v_mfma_f32_16x16x32_bf16 v[236:239], v[92:95], v[204:207], v[236:239]
    v_mfma_f32_16x16x32_bf16 v[240:243], v[92:95], v[208:211], v[240:243]
    v_mfma_f32_16x16x32_bf16 v[244:247], v[92:95], v[212:215], v[244:247]
    v_mfma_f32_16x16x32_bf16 v[248:251], v[92:95], v[216:219], v[248:251]
    v_mfma_f32_16x16x32_bf16 v[252:255], v[92:95], v[220:223], v[252:255]
    s_nop 1
    s_mov_b32 exec_hi, 0
    v_min_u32_dpp v40, v224, v44 quad_perm:[0,1,2,3] row_mask:0x1 bank_mask:0xf
    v_min_u32_dpp v41, v228, v44 quad_perm:[0,1,2,3] row_mask:0x1 bank_mask:0xf
    v_min_u32_dpp v42, v232, v44 quad_perm:[0,1,2,3] row_mask:0x1 bank_mask:0xf
    v_min_u32_dpp v43, v236, v44 quad_perm:[0,1,2,3] row_mask:0x1 bank_mask:0xf
    v_min_u32_dpp v40, v240, v44 quad_perm:[0,1,2,3] row_mask:0x2 bank_mask:0xf
    v_min_u32_dpp v41, v244, v44 quad_perm:[0,1,2,3] row_mask:0x2 bank_mask:0xf
    v_min_u32_dpp v42, v248, v44 quad_perm:[0,1,2,3] row_mask:0x2 bank_mask:0xf
    v_min_u32_dpp v43, v252, v44 quad_perm:[0,1,2,3] row_mask:0x2 bank_mask:0xf
    buffer_store_dwordx4 v[40:43], v30, s[44:47], 0 offen sc1
    s_mov_b32 exec_hi, -1
    s_cmp_lg_u32 s3, 0
    s_cbranch_scc1 L_fin
    s_sleep 7
    buffer_load_dwordx4 v[64:67], v39, s[44:47], 0 offen sc1
    buffer_load_dwordx4 v[68:71], v39, s[44:47], 0 offen offset:1024 sc1
    ds_read_b32 v18, v51 offset:4160
    s_sleep 3
L_poll:
    buffer_load_dwordx4 v[72:75], v39, s[44:47], 0 offen sc1
    buffer_load_dwordx4 v[76:79], v39, s[44:47], 0 offen offset:1024 sc1
    s_waitcnt vmcnt(2)
    v_max3_u32 v16, v64, v65, v66
    v_max3_u32 v17, v67, v68, v69
    v_max3_u32 v16, v16, v70, v71
    v_pk_add_f32 v[8:9], v[64:65], v[68:69]
    v_pk_add_f32 v[10:11], v[66:67], v[70:71]
    v_max_u32 v16, v16, v17
    v_cmp_eq_u32 vcc, -1, v16
    s_nop 0
    s_cbranch_vccz L_got
    buffer_load_dwordx4 v[64:67], v39, s[44:47], 0 offen sc1
    buffer_load_dwordx4 v[68:71], v39, s[44:47], 0 offen offset:1024 sc1
    s_waitcnt vmcnt(2)
    v_max3_u32 v16, v72, v73, v74
    v_max3_u32 v17, v75, v76, v77
    v_max3_u32 v16, v16, v78, v79
    v_pk_add_f32 v[8:9], v[72:73], v[76:77]
    v_pk_add_f32 v[10:11], v[74:75], v[78:79]
    v_max_u32 v16, v16, v17
    v_cmp_eq_u32 vcc, -1, v16
    s_nop 0
    s_cbranch_vccz L_got
    s_add_u32 s7, s7, 1
    s_cmp_lt_u32 s7, 0x400000
    s_cbranch_scc1 L_poll
L_got:
    v_permlane32_swap_b32 v8, v10
    v_permlane32_swap_b32 v9, v11
    v_add_f32 v8, v8, v10
    v_add_f32 v9, v9, v11
    s_nop 1
    v_permlane16_swap_b32 v8, v9
    v_add_f32 v8, v8, v9
    s_nop 1
    v_add_f32_dpp v8, v8, v8 row_ror:4 row_mask:0xf bank_mask:0xf
    s_nop 1
    v_add_f32_dpp v8, v8, v8 row_ror:8 row_mask:0xf bank_mask:0xf
    v_cvt_pk_bf16_f32 v8, v8, v8
    v_and_b32 v8, s36, v8
    v_add_f32 v8, v8, v50
    v_cvt_pk_bf16_f32 v8, v8, v8
    v_and_b32 v8, s36, v8
    s_waitcnt lgkmcnt(0)
    v_add_f32 v8, v8, v18
    v_cvt_pk_bf16_f32 v8, v8, v8
    s_mov_b32 exec_lo, 0x000f000f
    s_mov_b32 exec_hi, 0x000f000f
    buffer_store_short v8, v49, s[48:51], 0 offen
L_fin:
    s_cmp_lg_u32 s17, 0
    s_cbranch_scc1 L_real
L_end:
    s_endpgm
L_step:
    s_cmp_lg_u32 s3, 2
    s_cbranch_scc1 L_step1
    s_call_b64 s[84:85], L_svc
L_step1:
    ds_read2_b32 v[52:53], v56 offset0:45 offset1:47
    ds_read2_b32 v[54:55], v56 offset0:49 offset1:51
    s_waitcnt lgkmcnt(0)
    v_min_u32 v52, v52, v53
    v_min3_u32 v52, v52, v54, v55
    s_nop 0
    v_readfirstlane_b32 s6, v52
    s_nop 0
    s_cmp_ge_u32 s6, s42
    s_cbranch_scc1 L_go
    s_sleep 2
    s_branch L_step
L_go:
    s_cmp_lg_u32 s3, 0
    s_cbranch_scc1 L_ret
    ds_read2_b32 v[52:53], v56 offset0:44 offset1:46
    ds_read2_b32 v[54:55], v56 offset0:48 offset1:50
    s_sub_u32 s6, s41, 4352
    s_cmp_lt_u32 s42, 3
    s_cbranch_scc1 L_noref
    s_load_dword s80, s[28:29], s6
    s_add_u32 s6, s6, 256
    s_load_dword s81, s[28:29], s6
    s_add_u32 s6, s6, 256
    s_load_dword s82, s[28:29], s6
    s_add_u32 s6, s6, 256
    s_load_dword s83, s[28:29], s6
    s_add_u32 s6, s6, 256
    s_load_dword s84, s[28:29], s6
    s_add_u32 s6, s6, 256
    s_load_dword s85, s[28:29], s6
    s_add_u32 s6, s6, 256
    s_load_dword s86, s[28:29], s6
    s_add_u32 s6, s6, 256
    s_load_dword s87, s[28:29], s6
L_noref:
    s_waitcnt lgkmcnt(0)
    v_sub_u32 v53, v53, v52
    v_sub_u32 v54, v54, v52
    v_sub_u32 v55, v55, v52
    v_add3_u32 v53, v53, v54, v55
    v_ashrrev_i32 v53, 2, v53
    v_add_u32 v53, v52, v53
    s_nop 0
    v_readfirstlane_b32 s12, v53
    s_cmp_lg_u32 s30, s31
    s_cbranch_scc1 L_nopub
    s_mul_i32 s6, s30, 256
    s_add_u32 s6, s6, s41
    v_lshl_add_u32 v52, v5, 2, s6
    s_mov_b32 exec_hi, 0
    global_store_dword v52, v53, s[28:29] sc1
    s_mov_b64 exec, -1
L_nopub:
    s_cmp_lt_u32 s42, 3
    s_cbranch_scc1 L_upd
    s_sub_u32 s80, s12, s80
    s_cmp_lt_u32 s80, 6000
    s_cselect_b32 s80, s80, 0
    s_sub_u32 s81, s12, s81
    s_cmp_lt_u32 s81, 6000
    s_cselect_b32 s81, s81, 0
    s_sub_u32 s82, s12, s82
    s_cmp_lt_u32 s82, 6000
    s_cselect_b32 s82, s82, 0
    s_sub_u32 s83, s12, s83
    s_cmp_lt_u32 s83, 6000
    s_cselect_b32 s83, s83, 0
    s_sub_u32 s84, s12, s84
    s_cmp_lt_u32 s84, 6000
    s_cselect_b32 s84, s84, 0
    s_sub_u32 s85, s12, s85
    s_cmp_lt_u32 s85, 6000
    s_cselect_b32 s85, s85, 0
    s_sub_u32 s86, s12, s86
    s_cmp_lt_u32 s86, 6000
    s_cselect_b32 s86, s86, 0
    s_sub_u32 s87, s12, s87
    s_cmp_lt_u32 s87, 6000
    s_cselect_b32 s87, s87, 0
    s_mov_b32 s6, s80
    s_mov_b32 s13, s80
    s_mov_b32 s18, s80
    s_add_u32 s6, s6, s81
    s_max_u32 s13, s13, s81
    s_min_u32 s18, s18, s81
    s_add_u32 s6, s6, s82
    s_max_u32 s13, s13, s82
    s_min_u32 s18, s18, s82
    s_add_u32 s6, s6, s83
    s_max_u32 s13, s13, s83
    s_min_u32 s18, s18, s83
    s_add_u32 s6, s6, s84
    s_max_u32 s13, s13, s84
    s_min_u32 s18, s18, s84
    s_add_u32 s6, s6, s85
    s_max_u32 s13, s13, s85
    s_min_u32 s18, s18, s85
    s_add_u32 s6, s6, s86
    s_max_u32 s13, s13, s86
    s_min_u32 s18, s18, s86
    s_add_u32 s6, s6, s87
    s_max_u32 s13, s13, s87
    s_min_u32 s18, s18, s87
    s_lshr_b32 s6, s6, 3
    s_sub_u32 s18, s6, s18
    s_sub_u32 s80, s12, s6
    s_sub_u32 s81, s80, s43
    s_sub_u32 s82, s12, s4
    s_cmp_lt_u32 s81, 1500
    s_cselect_b32 s81, s81, s82
    s_cselect_b32 s83, 1, 0
    s_mov_b32 s43, s80
    s_lshl_b32 s81, s81, 4
    s_min_u32 s86, s81, s59
    s_max_u32 s87, s81, s59
    s_mov_b32 s59, s81
    s_cmp_eq_u32 s19, 0
    s_cselect_b32 s82, s81, s19
    s_add_u32 s84, s82, 400
    s_min_u32 s84, s84, s81
    s_sub_i32 s84, s84, s82
    s_ashr_i32 s84, s84, 2
    s_add_u32 s82, s82, s84
    s_min_u32 s82, s82, s87
    s_cmp_lt_u32 s42, 5
    s_cselect_b32 s83, 0, s83
    s_mul_i32 s19, s82, s83
    s_sub_u32 s81, s81, 48
    s_max_u32 s81, s81, s82
    s_mul_i32 s6, s81, 44
    s_lshr_b32 s6, s6, 9
    s_add_u32 s6, s6, s80
    s_sub_i32 s85, s18, 35
    s_min_i32 s85, s85, 110
    s_cmp_lt_u32 s42, 9
    s_cselect_b32 s84, 30, 20
    s_max_i32 s85, s85, s84
    s_add_i32 s6, s6, s85
    s_sub_i32 s18, 125, s18
    s_max_i32 s18, s18, -30
    s_min_i32 s84, s18, 0
    s_cmp_gt_u32 s86, 7168
    s_cselect_b32 s18, s84, s18
    s_add_i32 s18, s18, s85
    s_add_i32 s18, s18, 2000
    s_sub_i32 s84, s81, s86
    s_max_i32 s84, s84, 0
    s_mul_i32 s84, s84, 5
    s_lshr_b32 s84, s84, 5
    s_cmp_lt_u32 s42, 5
    s_cselect_b32 s84, 1500, s84
    s_sub_u32 s83, s42, 7
    s_cmp_lt_u32 s83, 3
    s_cselect_b32 s83, s86, 0
    s_cmp_gt_u32 s83, 7168
    s_cselect_b32 s84, 1500, s84
    s_add_u32 s18, s18, s84
    v_mov_b32 v55, s18
    ds_write_b32 v56, v55 offset:140
    s_mul_i32 s81, s81, 4
    s_add_u32 s81, s81, 256
    s_lshr_b32 s81, s81, 9
    s_add_u32 s82, s12, 0x40000000
    s_cmp_lg_u32 s13, 0
    s_cselect_b32 s6, s6, s82
    v_mov_b32 v52, s6
    v_mov_b32 v53, s81
    v_mov_b32 v54, s42
    ds_write_b96 v56, v[52:54] offset:128
L_upd:
    s_mov_b32 s4, s12
L_ret:
    s_add_u32 s42, s42, 1
    s_add_u32 s41, s41, 4352
    s_setpc_b64 s[56:57]
L_lat:
    s_waitcnt lgkmcnt(0)
    s_memtime s[80:81]
    s_waitcnt lgkmcnt(0)
    s_load_dword s84, s[42:43], s41
    s_waitcnt lgkmcnt(0)
    s_memtime s[82:83]
    s_waitcnt lgkmcnt(0)
    s_sub_u32 s82, s82, s80
    s_min_u32 s82, s82, 2200
    s_sub_u32 s83, 0, s82
    s_bitcmp1_b32 s41, 13
    s_cselect_b32 s82, s83, s82
    s_cselect_b32 s83, 0x300, 0
    s_add_u32 s59, s59, s82
    s_xor_b32 s41, s41, 0x2000
    s_add_u32 s41, s41, s83
    s_setpc_b64 s[56:57]
L_svc:
    s_cmp_ge_u32 s80, 4
    s_cbranch_scc1 L_svr
    s_lshl_b32 s83, s80, 9
    v_add_u32 v62, s83, v58
    s_cmp_lt_u32 s80, 2
    s_cselect_b32 s6, 0x20400, 0
    s_add_u32 s83, s83, s6
    s_cmp_lg_u32 s81, 0
    s_cbranch_scc1 L_svp
    ds_read_b128 v[52:55], v56 offset:224
    s_waitcnt lgkmcnt(0)
    v_min_u32 v52, v52, v53
    v_min3_u32 v52, v52, v54, v55
    s_nop 0
    v_readfirstlane_b32 s6, v52
    s_nop 0
    s_cmp_lt_u32 s6, s80
    s_cbranch_scc1 L_svr
    ds_read_b128 v[52:55], v62 offset:10240
    s_waitcnt lgkmcnt(0)
    s_cmp_lg_u32 s80, 3
    s_cbranch_scc1 L_svs
    ds_read_b64 v[60:61], v62 offset:10752
    s_waitcnt lgkmcnt(0)
    v_pk_add_f32 v[52:53], v[52:53], v[60:61]
    ds_read_b64 v[60:61], v62 offset:10760
    s_waitcnt lgkmcnt(0)
    v_pk_add_f32 v[54:55], v[54:55], v[60:61]
L_svs:
    v_min_u32 v52, -2, v52
    v_min_u32 v53, -2, v53
    v_min_u32 v54, -2, v54
    v_min_u32 v55, -2, v55
    s_mov_b32 exec_hi, 0
    buffer_store_dwordx4 v[52:55], v63, s[44:47], s83 offen sc1
    s_mov_b32 exec_hi, -1
    s_mov_b32 s81, 1
    s_nop 0
    s_setpc_b64 s[84:85]
L_svp:
    s_waitcnt vmcnt(0)
    s_mov_b32 exec_hi, 0
    buffer_load_dwordx4 v[52:55], v59, s[44:47], s83 offen sc1
    s_add_u32 s82, s82, 1
    s_waitcnt vmcnt(0)
    v_max3_u32 v60, v52, v53, v54
    v_max_u32 v60, v60, v55
    v_cmp_eq_u32 vcc, -1, v60
    s_nop 0
    s_cbranch_vccz L_svg
    s_cmp_lt_u32 s82, 0x400000
    s_cbranch_scc1 L_svx
L_svg:
    s_cmp_lg_u32 s80, 3
    s_cbranch_scc1 L_svw
    ds_read_b64 v[60:61], v62 offset:11264
    ds_read_b64 v[32:33], v62 offset:11776
    s_waitcnt lgkmcnt(0)
    v_pk_add_f32 v[60:61], v[60:61], v[32:33]
    v_pk_add_f32 v[52:53], v[52:53], v[60:61]
    ds_read_b64 v[60:61], v62 offset:11272
    ds_read_b64 v[32:33], v62 offset:11784
    s_waitcnt lgkmcnt(0)
    v_pk_add_f32 v[60:61], v[60:61], v[32:33]
    v_pk_add_f32 v[54:55], v[54:55], v[60:61]
L_svw:
    ds_write_b128 v62, v[52:55] offset:8192
    s_add_u32 s80, s80, 1
    s_mov_b32 s81, 0
    v_mov_b32 v60, s80
    s_waitcnt lgkmcnt(0)
    ds_write_b32 v56, v60 offset:240
L_svx:
    s_mov_b32 exec_hi, -1
L_svr:
    s_setpc_b64 s[84:85]
L_last:
.section .rodata,"a"
.p2align 6
.amdhsa_kernel parallel_sum__mha_block_cached__mixer_token_mlp__decode_kernel
  .amdhsa_next_free_vgpr 256
  .amdhsa_next_free_sgpr 97
  .amdhsa_accum_offset 256
  .amdhsa_group_segment_fixed_size 0
  .amdhsa_kernarg_size 104
  .amdhsa_user_sgpr_count 2
  .amdhsa_user_sgpr_kernarg_segment_ptr 1
  .amdhsa_system_sgpr_workgroup_id_x 1
.end_amdhsa_kernel
```
